```python
import torch

def _softmax(x, axis=-1):
    return torch.softmax(x, dim=axis)
def _gelu(x):
    return torch.nn.functional.gelu(x, approximate="tanh")
def _silu(x):
    return torch.nn.functional.silu(x)
def _sigmoid(x):
    return torch.sigmoid(x)
def _layernorm(x, axis=-1, eps=1e-5):
    m = x.mean(dim=axis, keepdim=True)
    v = x.var(dim=axis, keepdim=True, unbiased=False)
    return (x - m) / torch.sqrt(v + eps)
def _scatter_add(tgt, idx, src, axis=0):
    return tgt.clone().index_add_(axis, idx, src)
def _segment_sum(src, seg, n):
    out = torch.zeros((n,) + src.shape[1:], dtype=src.dtype)
    return out.index_add_(0, seg, src)
def _pad(x, pw):
    flat = tuple(v for pair in reversed(pw) for v in pair)
    return torch.nn.functional.pad(x, flat)

kernel_name = 'gated_mix__gqa_block_cached__glu_gated_bilinear__decode'

def setup_inputs():

    _w = (lambda a: (lambda t: t.to(torch.bfloat16) if t.is_floating_point() else t)(torch.as_tensor(a)))
    def _A_setup():
        B, Sq, D = 1, 1, 640
        Hq, Hkv, Sk, Dh = 32, 32, 8192, 192
        assert Hq % Hkv == 0, (Hq, Hkv)
        return {
            "x": _w((lambda *s: torch.randn(*s, dtype=torch.bfloat16) * 0.05)(B, Sq, D)),
            "k_cache": _w((lambda *s: torch.randn(*s, dtype=torch.bfloat16) * 3.2)(B, Hkv, Sk, Dh)),
            "v_cache": _w((lambda *s: torch.randn(*s, dtype=torch.bfloat16) * 0.05)(B, Hkv, Sk, Dh)),
            "wq": _w((lambda *s: torch.randn(*s, dtype=torch.bfloat16) * 3.2)(D, Hq * Dh) * (D ** -0.5)),
            "wo": _w((lambda *s: torch.randn(*s, dtype=torch.bfloat16) * 0.05)(Hq * Dh, D) * ((Hq * Dh) ** -0.5)),
        }
    _A_in = _A_setup()

    def _B_setup():
        B, S, D, F = 1, 1, 640, 1536
        return {
            "x": _w((lambda *s: torch.randn(*s, dtype=torch.bfloat16) * 0.05)(B, S, D)),
            "w_gate": _w((lambda *s: torch.randn(*s, dtype=torch.bfloat16) * 0.2)(D, F) * (D ** -0.5)),
            "w_up": _w((lambda *s: torch.randn(*s, dtype=torch.bfloat16) * 0.2)(D, F) * (D ** -0.5)),
            "w_down": _w((lambda *s: torch.randn(*s, dtype=torch.bfloat16) * 0.2)(F, D) * (F ** -0.5)),
        }
    _B_in = _B_setup()

    return {
        "A_x": _A_in["x"],
        "A_k_cache": _A_in["k_cache"],
        "A_v_cache": _A_in["v_cache"],
        "A_wq": _A_in["wq"],
        "A_wo": _A_in["wo"],
        "B_x": _B_in["x"],
        "B_w_gate": _B_in["w_gate"],
        "B_w_up": _B_in["w_up"],
        "B_w_down": _B_in["w_down"],
        "gate_w": _w((lambda *s: torch.randn(*s, dtype=torch.bfloat16) * 0.05)(640) * 16.0),
    }

def reference(A_x, A_k_cache, A_v_cache, A_wq, A_wo, B_x, B_w_gate, B_w_up, B_w_down, gate_w):
    def _A_ref(x, k_cache, v_cache, wq, wo):
        B, Sq, D = x.shape
        Hq, Dh = 32, 192
        Hkv = k_cache.shape[1]
        rep = Hq // Hkv
        q = (lambda x, *d: x.permute(*d))((x @ wq).reshape(B, Sq, Hq, Dh), 0, 2, 1, 3)
        k = (lambda x, n, axis: torch.repeat_interleave(x, n, dim=axis))(k_cache, rep, axis=1)
        v = (lambda x, n, axis: torch.repeat_interleave(x, n, dim=axis))(v_cache, rep, axis=1)
        scores = torch.einsum("bhqd,bhkd->bhqk", q, k) * (Dh ** -0.5)
        p = _softmax(scores, axis=-1)
        o = torch.einsum("bhqk,bhkd->bhqd", p, v)
        return (lambda x, *d: x.permute(*d))(o, 0, 2, 1, 3).reshape(B, Sq, Hq * Dh) @ wo

    def _B_ref(x, w_gate, w_up, w_down):
        g = torch.einsum("bsd,df->bsf", x, w_gate)
        u = torch.einsum("bsd,df->bsf", x, w_up)
        h = g * u
        return torch.einsum("bsf,fd->bsd", h, w_down)

    x = A_x
    g = _sigmoid((x * gate_w).sum(-1, keepdims=True))
    a = _A_ref(x, A_k_cache, A_v_cache, A_wq, A_wo)
    b = _B_ref(x, B_w_gate, B_w_up, B_w_down)
    return g * a + (1 - g) * b
```

```asm
; @launch grid=(256,1,1) block=(512,1,1) lds=43264
.amdgcn_target "amdgcn-amd-amdhsa--gfx950"
.text
.globl gated_mix__gqa_block_cached__glu_gated_bilinear__decode_kernel
.p2align 8
.type gated_mix__gqa_block_cached__glu_gated_bilinear__decode_kernel,@function
gated_mix__gqa_block_cached__glu_gated_bilinear__decode_kernel:
    s_cmp_ge_u32 s2, 256
    s_cbranch_scc1 L_exit
    s_load_dwordx16 s[4:19], s[0:1], 0
    s_load_dwordx8 s[20:27], s[0:1], 64
    s_load_dwordx2 s[28:29], s[0:1], 96
    v_and_b32 v1, 63, v0
    v_lshrrev_b32 v4, 6, v0
    s_nop 0
    v_readfirstlane_b32 s82, v4
    s_and_b32 s80, s2, 7
    s_lshl_b32 s80, s80, 2
    s_lshr_b32 s81, s2, 3
    s_and_b32 s83, s81, 3
    s_add_u32 s80, s80, s83
    s_lshr_b32 s81, s2, 5
    s_mov_b32 s89, 0xffff0000
    v_lshrrev_b32 v4, 3, v1
    v_and_b32 v5, 7, v1
    v_lshlrev_b32 v5, 4, v5
    v_mul_u32_u24 v2, 0x180, v4
    v_add_u32 v2, v2, v5
    v_mul_u32_u24 v3, 12288, v4
    v_add_u32 v3, v3, v5
    v_mul_u32_u24 v7, 3072, v4
    v_add_u32 v7, v7, v5
    v_lshlrev_b32 v55, 1, v4
    v_mov_b32 v32, 0
    v_mov_b32 v33, 0
    v_mov_b32 v34, 0
    v_mov_b32 v35, 0
    v_mov_b32 v36, 0
    v_mov_b32 v37, 0
    v_mov_b32 v38, 0
    v_mov_b32 v39, 0
    v_mov_b32 v40, 0
    v_mov_b32 v41, 0
    v_mov_b32 v42, 0
    v_mov_b32 v43, 0
    v_mov_b32 v44, 0
    v_mov_b32 v45, 0
    v_mov_b32 v46, 0
    v_mov_b32 v47, 0
    v_mov_b32 v54, 0
    v_mov_b32 v60, 0
    v_mov_b32 v244, 0
    v_mov_b32 v245, 0
    v_mov_b32 v246, 0
    v_mov_b32 v247, 0
    v_mov_b32 v248, 0
    v_mov_b32 v249, 0
    v_mov_b32 v250, 0
    v_mov_b32 v251, 0
    v_mov_b32 v252, 0
    v_mov_b32 v253, 0
    v_mov_b32 v254, 0
    v_mov_b32 v255, 0
    s_mul_i32 s86, s81, 80
    s_mul_i32 s83, s82, 10
    s_add_u32 s86, s86, s83
    s_lshl_b32 s88, s86, 1
    s_mul_i32 s85, s86, 12288
    s_mul_i32 s83, s80, 384
    s_add_u32 s85, s85, s83
    s_add_u32 s84, s85, 98304
    s_mul_i32 s86, s86, 3072
    s_mul_i32 s83, s80, 96
    s_add_u32 s86, s86, s83
    s_add_u32 s90, s86, 24576
    s_mul_i32 s87, s80, 3145728
    s_mul_i32 s83, s81, 393216
    s_add_u32 s87, s87, s83
    s_mul_i32 s83, s82, 49152
    s_add_u32 s87, s87, s83
    s_lshl_b32 s91, s80, 8
    s_lshl_b32 s83, s81, 2
    s_add_u32 s91, s91, s83
    s_add_u32 s3, s91, 2097152
    s_waitcnt lgkmcnt(0)
    s_mov_b32 s44, s4
    s_and_b32 s45, s5, 0xffff
    s_mov_b32 s46, 1280
    s_mov_b32 s47, 0x00020000
    s_mov_b32 s48, s16
    s_and_b32 s49, s17, 0xffff
    s_mov_b32 s50, 1966080
    s_mov_b32 s51, 0x00020000
    s_mov_b32 s52, s18
    s_and_b32 s53, s19, 0xffff
    s_mov_b32 s54, 1966080
    s_mov_b32 s55, 0x00020000
    s_mov_b32 s40, s10
    s_and_b32 s41, s11, 0xffff
    s_mov_b32 s42, 7864320
    s_mov_b32 s43, 0x00020000
    s_mov_b32 s32, s6
    s_and_b32 s33, s7, 0xffff
    s_mov_b32 s34, 100663296
    s_mov_b32 s35, 0x00020000
    s_mov_b32 s56, s28
    s_and_b32 s57, s29, 0xffff
    s_mov_b32 s58, 402653184
    s_mov_b32 s59, 0x00020000
    buffer_load_ushort v53, v55, s[44:47], s88 offen
    buffer_load_dwordx4 v[232:235], v3, s[40:43], s85 offen offset:0 nt
    buffer_load_dwordx4 v[236:239], v3, s[40:43], s85 offen offset:128 nt
    buffer_load_dwordx4 v[240:243], v3, s[40:43], s85 offen offset:256 nt
    s_mov_b32 exec_lo, 0x3f3f3f3f
    s_mov_b32 exec_hi, 0x3f3f3f3f
    buffer_load_dwordx4 v[32:35], v7, s[48:51], s86 offen nt
    buffer_load_dwordx4 v[40:43], v7, s[52:55], s86 offen nt
    s_mov_b64 exec, 0x3f3f
    buffer_load_dwordx4 v[36:39], v7, s[48:51], s90 offen nt
    buffer_load_dwordx4 v[44:47], v7, s[52:55], s90 offen nt
    s_mov_b64 exec, 0xffff
    buffer_load_ushort v54, v55, s[44:47], s88 offen offset:16
    buffer_load_dwordx4 v[244:247], v3, s[40:43], s84 offen offset:0 nt
    buffer_load_dwordx4 v[248:251], v3, s[40:43], s84 offen offset:128 nt
    buffer_load_dwordx4 v[252:255], v3, s[40:43], s84 offen offset:256 nt
    s_mov_b64 exec, -1
    s_mov_b32 s36, s8
    s_and_b32 s37, s9, 0xffff
    s_mov_b32 s38, 100663296
    s_mov_b32 s39, 0x00020000
    s_mov_b32 s68, s22
    s_and_b32 s69, s23, 0xffff
    s_mov_b32 s70, 1280
    s_mov_b32 s71, 0x00020000
    s_mov_b32 s60, s12
    s_and_b32 s61, s13, 0xffff
    s_mov_b32 s62, 7864320
    s_mov_b32 s63, 0x00020000
    s_mov_b32 s64, s20
    s_and_b32 s65, s21, 0xffff
    s_mov_b32 s66, 1966080
    s_mov_b32 s67, 0x00020000
    s_mov_b32 s72, s24
    s_and_b32 s73, s25, 0xffff
    s_mov_b32 s74, 1280
    s_mov_b32 s75, 0x00020000
    s_mov_b32 s76, s26
    s_and_b32 s77, s27, 0xffff
    s_mov_b32 s78, 256
    s_mov_b32 s79, 0x00020000
    s_cmp_eq_u32 s82, 0
    s_cbranch_scc1 L_nokpre
    s_add_u32 s88, s87, 0
    buffer_load_dwordx4 v[64:67], v2, s[32:35], s88 offen offset:0 nt
    buffer_load_dwordx4 v[68:71], v2, s[32:35], s88 offen offset:128 nt
    buffer_load_dwordx4 v[72:75], v2, s[32:35], s88 offen offset:256 nt
    s_add_u32 s88, s87, 3072
    buffer_load_dwordx4 v[76:79], v2, s[32:35], s88 offen offset:0 nt
    buffer_load_dwordx4 v[80:83], v2, s[32:35], s88 offen offset:128 nt
    buffer_load_dwordx4 v[84:87], v2, s[32:35], s88 offen offset:256 nt
    s_add_u32 s88, s87, 6144
    buffer_load_dwordx4 v[88:91], v2, s[32:35], s88 offen offset:0 nt
    buffer_load_dwordx4 v[92:95], v2, s[32:35], s88 offen offset:128 nt
    buffer_load_dwordx4 v[96:99], v2, s[32:35], s88 offen offset:256 nt
L_nokpre:
    s_nop 3
    s_cmp_eq_u32 s82, 0
    s_cbranch_scc0 L_w17
    s_waitcnt vmcnt(0)
L_w17:
    s_nop 3
    s_waitcnt vmcnt(9)
    v_lshlrev_b32 v53, 16, v53
    v_lshlrev_b32 v54, 16, v54
    v_lshlrev_b32 v60, 16, v32
    v_and_b32 v61, s89, v32
    v_lshlrev_b32 v62, 16, v36
    v_and_b32 v63, s89, v36
    v_mul_f32 v220, v53, v60
    v_mul_f32 v221, v53, v61
    v_fmac_f32 v220, v54, v62
    v_fmac_f32 v221, v54, v63
    v_lshlrev_b32 v60, 16, v33
    v_and_b32 v61, s89, v33
    v_lshlrev_b32 v62, 16, v37
    v_and_b32 v63, s89, v37
    v_mul_f32 v222, v53, v60
    v_mul_f32 v223, v53, v61
    v_fmac_f32 v222, v54, v62
    v_fmac_f32 v223, v54, v63
    v_lshlrev_b32 v60, 16, v34
    v_and_b32 v61, s89, v34
    v_lshlrev_b32 v62, 16, v38
    v_and_b32 v63, s89, v38
    v_mul_f32 v224, v53, v60
    v_mul_f32 v225, v53, v61
    v_fmac_f32 v224, v54, v62
    v_fmac_f32 v225, v54, v63
    v_lshlrev_b32 v60, 16, v35
    v_and_b32 v61, s89, v35
    v_lshlrev_b32 v62, 16, v39
    v_and_b32 v63, s89, v39
    v_mul_f32 v226, v53, v60
    v_mul_f32 v227, v53, v61
    v_fmac_f32 v226, v54, v62
    v_fmac_f32 v227, v54, v63
    v_lshlrev_b32 v60, 16, v40
    v_and_b32 v61, s89, v40
    v_lshlrev_b32 v62, 16, v44
    v_and_b32 v63, s89, v44
    v_mul_f32 v228, v53, v60
    v_mul_f32 v229, v53, v61
    v_fmac_f32 v228, v54, v62
    v_fmac_f32 v229, v54, v63
    v_lshlrev_b32 v60, 16, v41
    v_and_b32 v61, s89, v41
    v_lshlrev_b32 v62, 16, v45
    v_and_b32 v63, s89, v45
    v_mul_f32 v230, v53, v60
    v_mul_f32 v231, v53, v61
    v_fmac_f32 v230, v54, v62
    v_fmac_f32 v231, v54, v63
    v_lshlrev_b32 v60, 16, v42
    v_and_b32 v61, s89, v42
    v_lshlrev_b32 v62, 16, v46
    v_and_b32 v63, s89, v46
    v_mul_f32 v56, v53, v60
    v_mul_f32 v57, v53, v61
    v_fmac_f32 v56, v54, v62
    v_fmac_f32 v57, v54, v63
    v_lshlrev_b32 v60, 16, v43
    v_and_b32 v61, s89, v43
    v_lshlrev_b32 v62, 16, v47
    v_and_b32 v63, s89, v47
    v_mul_f32 v58, v53, v60
    v_mul_f32 v59, v53, v61
    v_fmac_f32 v58, v54, v62
    v_fmac_f32 v59, v54, v63
    v_lshlrev_b32 v60, 16, v232
    v_and_b32 v61, s89, v232
    v_lshlrev_b32 v62, 16, v244
    v_and_b32 v63, s89, v244
    v_mul_f32 v8, v53, v60
    v_mul_f32 v9, v53, v61
    v_fmac_f32 v8, v54, v62
    v_fmac_f32 v9, v54, v63
    v_lshlrev_b32 v60, 16, v233
    v_and_b32 v61, s89, v233
    v_lshlrev_b32 v62, 16, v245
    v_and_b32 v63, s89, v245
    v_mul_f32 v10, v53, v60
    v_mul_f32 v11, v53, v61
    v_fmac_f32 v10, v54, v62
    v_fmac_f32 v11, v54, v63
    v_lshlrev_b32 v60, 16, v234
    v_and_b32 v61, s89, v234
    v_lshlrev_b32 v62, 16, v246
    v_and_b32 v63, s89, v246
    v_mul_f32 v12, v53, v60
    v_mul_f32 v13, v53, v61
    v_fmac_f32 v12, v54, v62
    v_fmac_f32 v13, v54, v63
    v_lshlrev_b32 v60, 16, v235
    v_and_b32 v61, s89, v235
    v_lshlrev_b32 v62, 16, v247
    v_and_b32 v63, s89, v247
    v_mul_f32 v14, v53, v60
    v_mul_f32 v15, v53, v61
    v_fmac_f32 v14, v54, v62
    v_fmac_f32 v15, v54, v63
    v_lshlrev_b32 v60, 16, v236
    v_and_b32 v61, s89, v236
    v_lshlrev_b32 v62, 16, v248
    v_and_b32 v63, s89, v248
    v_mul_f32 v16, v53, v60
    v_mul_f32 v17, v53, v61
    v_fmac_f32 v16, v54, v62
    v_fmac_f32 v17, v54, v63
    v_lshlrev_b32 v60, 16, v237
    v_and_b32 v61, s89, v237
    v_lshlrev_b32 v62, 16, v249
    v_and_b32 v63, s89, v249
    v_mul_f32 v18, v53, v60
    v_mul_f32 v19, v53, v61
    v_fmac_f32 v18, v54, v62
    v_fmac_f32 v19, v54, v63
    v_lshlrev_b32 v60, 16, v238
    v_and_b32 v61, s89, v238
    v_lshlrev_b32 v62, 16, v250
    v_and_b32 v63, s89, v250
    v_mul_f32 v20, v53, v60
    v_mul_f32 v21, v53, v61
    v_fmac_f32 v20, v54, v62
    v_fmac_f32 v21, v54, v63
    v_lshlrev_b32 v60, 16, v239
    v_and_b32 v61, s89, v239
    v_lshlrev_b32 v62, 16, v251
    v_and_b32 v63, s89, v251
    v_mul_f32 v22, v53, v60
    v_mul_f32 v23, v53, v61
    v_fmac_f32 v22, v54, v62
    v_fmac_f32 v23, v54, v63
    v_lshlrev_b32 v60, 16, v240
    v_and_b32 v61, s89, v240
    v_lshlrev_b32 v62, 16, v252
    v_and_b32 v63, s89, v252
    v_mul_f32 v24, v53, v60
    v_mul_f32 v25, v53, v61
    v_fmac_f32 v24, v54, v62
    v_fmac_f32 v25, v54, v63
    v_lshlrev_b32 v60, 16, v241
    v_and_b32 v61, s89, v241
    v_lshlrev_b32 v62, 16, v253
    v_and_b32 v63, s89, v253
    v_mul_f32 v26, v53, v60
    v_mul_f32 v27, v53, v61
    v_fmac_f32 v26, v54, v62
    v_fmac_f32 v27, v54, v63
    v_lshlrev_b32 v60, 16, v242
    v_and_b32 v61, s89, v242
    v_lshlrev_b32 v62, 16, v254
    v_and_b32 v63, s89, v254
    v_mul_f32 v28, v53, v60
    v_mul_f32 v29, v53, v61
    v_fmac_f32 v28, v54, v62
    v_fmac_f32 v29, v54, v63
    v_lshlrev_b32 v60, 16, v243
    v_and_b32 v61, s89, v243
    v_lshlrev_b32 v62, 16, v255
    v_and_b32 v63, s89, v255
    v_mul_f32 v30, v53, v60
    v_mul_f32 v31, v53, v61
    v_fmac_f32 v30, v54, v62
    v_fmac_f32 v31, v54, v63
    v_permlane32_swap_b32 v220, v221
    v_permlane32_swap_b32 v222, v223
    v_permlane32_swap_b32 v224, v225
    v_permlane32_swap_b32 v226, v227
    v_permlane32_swap_b32 v228, v229
    v_permlane32_swap_b32 v230, v231
    v_permlane32_swap_b32 v56, v57
    v_permlane32_swap_b32 v58, v59
    v_add_f32 v220, v220, v221
    v_add_f32 v222, v222, v223
    v_add_f32 v224, v224, v225
    v_add_f32 v226, v226, v227
    v_add_f32 v228, v228, v229
    v_add_f32 v230, v230, v231
    v_add_f32 v56, v56, v57
    v_add_f32 v58, v58, v59
    v_permlane16_swap_b32 v220, v222
    v_permlane16_swap_b32 v224, v226
    v_permlane16_swap_b32 v228, v230
    v_permlane16_swap_b32 v56, v58
    v_add_f32 v220, v220, v222
    v_add_f32 v224, v224, v226
    v_add_f32 v228, v228, v230
    v_add_f32 v56, v56, v58
    v_add_f32_dpp v220, v220, v220 row_ror:8 row_mask:0xf bank_mask:0xf
    v_add_f32_dpp v224, v224, v224 row_ror:8 row_mask:0xf bank_mask:0xf
    v_add_f32_dpp v228, v228, v228 row_ror:8 row_mask:0xf bank_mask:0xf
    v_add_f32_dpp v56, v56, v56 row_ror:8 row_mask:0xf bank_mask:0xf
    v_permlane32_swap_b32 v8, v9
    v_permlane32_swap_b32 v10, v11
    v_permlane32_swap_b32 v12, v13
    v_permlane32_swap_b32 v14, v15
    v_permlane32_swap_b32 v16, v17
    v_permlane32_swap_b32 v18, v19
    v_permlane32_swap_b32 v20, v21
    v_permlane32_swap_b32 v22, v23
    v_permlane32_swap_b32 v24, v25
    v_permlane32_swap_b32 v26, v27
    v_permlane32_swap_b32 v28, v29
    v_permlane32_swap_b32 v30, v31
    v_add_f32 v8, v8, v9
    v_add_f32 v10, v10, v11
    v_add_f32 v12, v12, v13
    v_add_f32 v14, v14, v15
    v_add_f32 v16, v16, v17
    v_add_f32 v18, v18, v19
    v_add_f32 v20, v20, v21
    v_add_f32 v22, v22, v23
    v_add_f32 v24, v24, v25
    v_add_f32 v26, v26, v27
    v_add_f32 v28, v28, v29
    v_add_f32 v30, v30, v31
    v_permlane16_swap_b32 v8, v10
    v_permlane16_swap_b32 v12, v14
    v_permlane16_swap_b32 v16, v18
    v_permlane16_swap_b32 v20, v22
    v_permlane16_swap_b32 v24, v26
    v_permlane16_swap_b32 v28, v30
    v_add_f32 v8, v8, v10
    v_add_f32 v12, v12, v14
    v_add_f32 v16, v16, v18
    v_add_f32 v20, v20, v22
    v_add_f32 v24, v24, v26
    v_add_f32 v28, v28, v30
    v_add_f32_dpp v8, v8, v8 row_ror:8 row_mask:0xf bank_mask:0xf
    v_add_f32_dpp v12, v12, v12 row_ror:8 row_mask:0xf bank_mask:0xf
    v_add_f32_dpp v16, v16, v16 row_ror:8 row_mask:0xf bank_mask:0xf
    v_add_f32_dpp v20, v20, v20 row_ror:8 row_mask:0xf bank_mask:0xf
    v_add_f32_dpp v24, v24, v24 row_ror:8 row_mask:0xf bank_mask:0xf
    v_add_f32_dpp v28, v28, v28 row_ror:8 row_mask:0xf bank_mask:0xf
    v_and_b32 v4, 7, v1
    v_lshlrev_b32 v4, 5, v4
    v_bfe_u32 v5, v1, 4, 1
    v_lshlrev_b32 v5, 3, v5
    v_add_u32 v4, v4, v5
    v_bfe_u32 v5, v1, 5, 1
    v_lshlrev_b32 v5, 2, v5
    v_add_u32 v7, v4, v5
    s_mul_i32 s90, s82, 384
    v_add_u32 v60, s90, v7
    s_mul_i32 s90, s82, 768
    v_add_u32 v7, s90, v7
    ds_write_b32 v7, v8 offset:0
    ds_write_b32 v7, v12 offset:16
    ds_write_b32 v7, v16 offset:256
    ds_write_b32 v7, v20 offset:272
    ds_write_b32 v7, v24 offset:512
    ds_write_b32 v7, v28 offset:528
    s_mov_b32 exec_lo, 0x3f3f3f3f
    s_mov_b32 exec_hi, 0x3f3f3f3f
    ds_write_b32 v60, v220 offset:6144
    ds_write_b32 v60, v224 offset:6160
    ds_write_b32 v60, v228 offset:6336
    ds_write_b32 v60, v56 offset:6352
    s_mov_b64 exec, -1
    s_waitcnt lgkmcnt(0)
    s_barrier
    s_cmp_eq_u32 s82, 0
    s_cbranch_scc1 L_sync0
    s_waitcnt vmcnt(6)
    s_add_u32 s88, s87, 9216
    buffer_load_dwordx4 v[100:103], v2, s[32:35], s88 offen offset:0 nt
    buffer_load_dwordx4 v[104:107], v2, s[32:35], s88 offen offset:128 nt
    buffer_load_dwordx4 v[108:111], v2, s[32:35], s88 offen offset:256 nt
    s_waitcnt vmcnt(6)
    s_add_u32 s88, s87, 12288
    buffer_load_dwordx4 v[112:115], v2, s[32:35], s88 offen offset:0 nt
    buffer_load_dwordx4 v[116:119], v2, s[32:35], s88 offen offset:128 nt
    buffer_load_dwordx4 v[120:123], v2, s[32:35], s88 offen offset:256 nt
    s_waitcnt vmcnt(6)
    s_add_u32 s88, s87, 15360
    buffer_load_dwordx4 v[124:127], v2, s[32:35], s88 offen offset:0 nt
    buffer_load_dwordx4 v[128:131], v2, s[32:35], s88 offen offset:128 nt
    buffer_load_dwordx4 v[132:135], v2, s[32:35], s88 offen offset:256 nt
    s_waitcnt vmcnt(6)
    s_add_u32 s88, s87, 18432
    buffer_load_dwordx4 v[136:139], v2, s[32:35], s88 offen offset:0 nt
    buffer_load_dwordx4 v[140:143], v2, s[32:35], s88 offen offset:128 nt
    buffer_load_dwordx4 v[144:147], v2, s[32:35], s88 offen offset:256 nt
    s_waitcnt vmcnt(6)
    s_add_u32 s88, s87, 21504
    buffer_load_dwordx4 v[148:151], v2, s[32:35], s88 offen offset:0 nt
    buffer_load_dwordx4 v[152:155], v2, s[32:35], s88 offen offset:128 nt
    buffer_load_dwordx4 v[156:159], v2, s[32:35], s88 offen offset:256 nt
    s_waitcnt vmcnt(6)
    s_add_u32 s88, s87, 24576
    buffer_load_dwordx4 v[160:163], v2, s[32:35], s88 offen offset:0 nt
    buffer_load_dwordx4 v[164:167], v2, s[32:35], s88 offen offset:128 nt
    buffer_load_dwordx4 v[168:171], v2, s[32:35], s88 offen offset:256 nt
    s_waitcnt vmcnt(6)
    s_add_u32 s88, s87, 27648
    buffer_load_dwordx4 v[172:175], v2, s[32:35], s88 offen offset:0 nt
    buffer_load_dwordx4 v[176:179], v2, s[32:35], s88 offen offset:128 nt
    buffer_load_dwordx4 v[180:183], v2, s[32:35], s88 offen offset:256 nt
    s_waitcnt vmcnt(6)
    s_add_u32 s88, s87, 30720
    buffer_load_dwordx4 v[184:187], v2, s[32:35], s88 offen offset:0 nt
    buffer_load_dwordx4 v[188:191], v2, s[32:35], s88 offen offset:128 nt
    buffer_load_dwordx4 v[192:195], v2, s[32:35], s88 offen offset:256 nt
    s_waitcnt vmcnt(6)
    s_add_u32 s88, s87, 33792
    buffer_load_dwordx4 v[196:199], v2, s[32:35], s88 offen offset:0 nt
    buffer_load_dwordx4 v[200:203], v2, s[32:35], s88 offen offset:128 nt
    buffer_load_dwordx4 v[204:207], v2, s[32:35], s88 offen offset:256 nt
    s_waitcnt vmcnt(6)
    s_add_u32 s88, s87, 36864
    buffer_load_dwordx4 v[208:211], v2, s[32:35], s88 offen offset:0 nt
    buffer_load_dwordx4 v[212:215], v2, s[32:35], s88 offen offset:128 nt
    buffer_load_dwordx4 v[216:219], v2, s[32:35], s88 offen offset:256 nt
    s_waitcnt vmcnt(6)
    s_add_u32 s88, s87, 39936
    buffer_load_dwordx4 v[220:223], v2, s[32:35], s88 offen offset:0 nt
    buffer_load_dwordx4 v[224:227], v2, s[32:35], s88 offen offset:128 nt
    buffer_load_dwordx4 v[228:231], v2, s[32:35], s88 offen offset:256 nt
    s_waitcnt vmcnt(6)
    s_add_u32 s88, s87, 43008
    buffer_load_dwordx4 v[232:235], v2, s[32:35], s88 offen offset:0 nt
    buffer_load_dwordx4 v[236:239], v2, s[32:35], s88 offen offset:128 nt
    buffer_load_dwordx4 v[240:243], v2, s[32:35], s88 offen offset:256 nt
    s_waitcnt vmcnt(6)
    s_add_u32 s88, s87, 46080
    buffer_load_dwordx4 v[244:247], v2, s[32:35], s88 offen offset:0 nt
    buffer_load_dwordx4 v[248:251], v2, s[32:35], s88 offen offset:128 nt
    buffer_load_dwordx4 v[252:255], v2, s[32:35], s88 offen offset:256 nt
    s_branch L_q_join
L_sync0:
    s_nop 3
    v_lshlrev_b32 v4, 2, v1
    ds_read_b32 v64, v4 offset:0
    ds_read_b32 v72, v4 offset:256
    ds_read_b32 v80, v4 offset:512
    ds_read_b32 v88, v4 offset:6144
    ds_read_b32 v96, v4 offset:6336
    ds_read_b32 v65, v4 offset:768
    ds_read_b32 v73, v4 offset:1024
    ds_read_b32 v81, v4 offset:1280
    ds_read_b32 v89, v4 offset:6528
    ds_read_b32 v97, v4 offset:6720
    ds_read_b32 v66, v4 offset:1536
    ds_read_b32 v74, v4 offset:1792
    ds_read_b32 v82, v4 offset:2048
    ds_read_b32 v90, v4 offset:6912
    ds_read_b32 v98, v4 offset:7104
    ds_read_b32 v67, v4 offset:2304
    ds_read_b32 v75, v4 offset:2560
    ds_read_b32 v83, v4 offset:2816
    ds_read_b32 v91, v4 offset:7296
    ds_read_b32 v99, v4 offset:7488
    ds_read_b32 v68, v4 offset:3072
    ds_read_b32 v76, v4 offset:3328
    ds_read_b32 v84, v4 offset:3584
    ds_read_b32 v92, v4 offset:7680
    ds_read_b32 v100, v4 offset:7872
    ds_read_b32 v69, v4 offset:3840
    ds_read_b32 v77, v4 offset:4096
    ds_read_b32 v85, v4 offset:4352
    ds_read_b32 v93, v4 offset:8064
    ds_read_b32 v101, v4 offset:8256
    ds_read_b32 v70, v4 offset:4608
    ds_read_b32 v78, v4 offset:4864
    ds_read_b32 v86, v4 offset:5120
    ds_read_b32 v94, v4 offset:8448
    ds_read_b32 v102, v4 offset:8640
    ds_read_b32 v71, v4 offset:5376
    ds_read_b32 v79, v4 offset:5632
    ds_read_b32 v87, v4 offset:5888
    ds_read_b32 v95, v4 offset:8832
    ds_read_b32 v103, v4 offset:9024
    s_waitcnt lgkmcnt(0)
    v_add_f32 v64, v64, v65
    v_add_f32 v66, v66, v67
    v_add_f32 v68, v68, v69
    v_add_f32 v70, v70, v71
    v_add_f32 v64, v64, v66
    v_add_f32 v68, v68, v70
    v_add_f32 v64, v64, v68
    v_add_f32 v72, v72, v73
    v_add_f32 v74, v74, v75
    v_add_f32 v76, v76, v77
    v_add_f32 v78, v78, v79
    v_add_f32 v72, v72, v74
    v_add_f32 v76, v76, v78
    v_add_f32 v72, v72, v76
    v_add_f32 v80, v80, v81
    v_add_f32 v82, v82, v83
    v_add_f32 v84, v84, v85
    v_add_f32 v86, v86, v87
    v_add_f32 v80, v80, v82
    v_add_f32 v84, v84, v86
    v_add_f32 v80, v80, v84
    v_add_f32 v88, v88, v89
    v_add_f32 v90, v90, v91
    v_add_f32 v92, v92, v93
    v_add_f32 v94, v94, v95
    v_add_f32 v88, v88, v90
    v_add_f32 v92, v92, v94
    v_add_f32 v88, v88, v92
    v_add_f32 v96, v96, v97
    v_add_f32 v98, v98, v99
    v_add_f32 v100, v100, v101
    v_add_f32 v102, v102, v103
    v_add_f32 v96, v96, v98
    v_add_f32 v100, v100, v102
    v_add_f32 v96, v96, v100
    s_lshl_b32 s90, s80, 3
    s_add_u32 s90, s90, s81
    s_lshl_b32 s83, s90, 10
    s_add_u32 s83, s83, 3145728
    buffer_store_dword v64, v4, s[56:59], s83 offen offset:0 sc0 sc1
    buffer_store_dword v72, v4, s[56:59], s83 offen offset:256 sc0 sc1
    buffer_store_dword v80, v4, s[56:59], s83 offen offset:512 sc0 sc1
    s_lshl_b32 s90, s90, 9
    s_add_u32 s90, s90, 524288
    s_mov_b32 exec_hi, 0xffff
    buffer_store_dword v88, v4, s[56:59], s90 offen sc0 sc1
    buffer_store_dword v96, v4, s[56:59], s90 offen offset:192 sc0 sc1
    s_mov_b64 exec, 1
    v_mov_b32 v60, 0
    buffer_store_dword v60, v60, s[56:59], s3 offen sc0 sc1
    s_waitcnt vmcnt(0)
    v_mov_b32 v56, 1
    s_lshl_b32 s90, s80, 2
    v_mov_b32 v57, s90
    buffer_atomic_add v56, v57, s[76:79], 0 offen sc1
    s_mov_b64 exec, -1
    v_mov_b32 v57, s90
    s_mov_b32 s83, 0
    s_sleep 100
L_qpoll:
    s_nop 3
    buffer_load_dword v56, v57, s[76:79], 0 offen sc0 sc1
    s_waitcnt vmcnt(0)
    v_readfirstlane_b32 s90, v56
    s_nop 1
    s_cmp_ge_u32 s90, 8
    s_cbranch_scc1 L_qready
    s_add_u32 s83, s83, 1
    s_cmp_ge_u32 s83, 0x400000
    s_cbranch_scc1 L_qready
    s_sleep 16
    s_branch L_qpoll
L_qready:
    s_nop 3
    s_lshl_b32 s83, s80, 13
    s_add_u32 s83, s83, 3145728
    buffer_load_dword v64, v4, s[56:59], s83 offen offset:0 sc0 sc1
    buffer_load_dword v72, v4, s[56:59], s83 offen offset:256 sc0 sc1
    buffer_load_dword v80, v4, s[56:59], s83 offen offset:512 sc0 sc1
    s_add_u32 s83, s83, 1024
    buffer_load_dword v65, v4, s[56:59], s83 offen offset:0 sc0 sc1
    buffer_load_dword v73, v4, s[56:59], s83 offen offset:256 sc0 sc1
    buffer_load_dword v81, v4, s[56:59], s83 offen offset:512 sc0 sc1
    s_add_u32 s83, s83, 1024
    buffer_load_dword v66, v4, s[56:59], s83 offen offset:0 sc0 sc1
    buffer_load_dword v74, v4, s[56:59], s83 offen offset:256 sc0 sc1
    buffer_load_dword v82, v4, s[56:59], s83 offen offset:512 sc0 sc1
    s_add_u32 s83, s83, 1024
    buffer_load_dword v67, v4, s[56:59], s83 offen offset:0 sc0 sc1
    buffer_load_dword v75, v4, s[56:59], s83 offen offset:256 sc0 sc1
    buffer_load_dword v83, v4, s[56:59], s83 offen offset:512 sc0 sc1
    s_add_u32 s83, s83, 1024
    buffer_load_dword v68, v4, s[56:59], s83 offen offset:0 sc0 sc1
    buffer_load_dword v76, v4, s[56:59], s83 offen offset:256 sc0 sc1
    buffer_load_dword v84, v4, s[56:59], s83 offen offset:512 sc0 sc1
    s_add_u32 s83, s83, 1024
    buffer_load_dword v69, v4, s[56:59], s83 offen offset:0 sc0 sc1
    buffer_load_dword v77, v4, s[56:59], s83 offen offset:256 sc0 sc1
    buffer_load_dword v85, v4, s[56:59], s83 offen offset:512 sc0 sc1
    s_add_u32 s83, s83, 1024
    buffer_load_dword v70, v4, s[56:59], s83 offen offset:0 sc0 sc1
    buffer_load_dword v78, v4, s[56:59], s83 offen offset:256 sc0 sc1
    buffer_load_dword v86, v4, s[56:59], s83 offen offset:512 sc0 sc1
    s_add_u32 s83, s83, 1024
    buffer_load_dword v71, v4, s[56:59], s83 offen offset:0 sc0 sc1
    buffer_load_dword v79, v4, s[56:59], s83 offen offset:256 sc0 sc1
    buffer_load_dword v87, v4, s[56:59], s83 offen offset:512 sc0 sc1
    s_waitcnt vmcnt(0)
    v_add_f32 v64, v64, v65
    v_add_f32 v66, v66, v67
    v_add_f32 v68, v68, v69
    v_add_f32 v70, v70, v71
    v_add_f32 v64, v64, v66
    v_add_f32 v68, v68, v70
    v_add_f32 v64, v64, v68
    v_add_f32 v72, v72, v73
    v_add_f32 v74, v74, v75
    v_add_f32 v76, v76, v77
    v_add_f32 v78, v78, v79
    v_add_f32 v72, v72, v74
    v_add_f32 v76, v76, v78
    v_add_f32 v72, v72, v76
    v_add_f32 v80, v80, v81
    v_add_f32 v82, v82, v83
    v_add_f32 v84, v84, v85
    v_add_f32 v86, v86, v87
    v_add_f32 v80, v80, v82
    v_add_f32 v84, v84, v86
    v_add_f32 v80, v80, v84
    v_lshlrev_b32 v4, 1, v1
    v_cvt_pk_bf16_f32 v64, v64, v64
    v_cvt_pk_bf16_f32 v72, v72, v72
    v_cvt_pk_bf16_f32 v80, v80, v80
    ds_write_b16 v4, v64 offset:9216
    ds_write_b16 v4, v72 offset:9344
    ds_write_b16 v4, v80 offset:9472
    s_waitcnt lgkmcnt(0)
L_q_join:
    s_nop 3
    s_barrier
    s_cmp_eq_u32 s82, 0
    s_cbranch_scc0 L_k0done
    s_add_u32 s88, s87, 0
    buffer_load_dwordx4 v[64:67], v2, s[32:35], s88 offen offset:0 nt
    buffer_load_dwordx4 v[68:71], v2, s[32:35], s88 offen offset:128 nt
    buffer_load_dwordx4 v[72:75], v2, s[32:35], s88 offen offset:256 nt
    s_add_u32 s88, s87, 3072
    buffer_load_dwordx4 v[76:79], v2, s[32:35], s88 offen offset:0 nt
    buffer_load_dwordx4 v[80:83], v2, s[32:35], s88 offen offset:128 nt
    buffer_load_dwordx4 v[84:87], v2, s[32:35], s88 offen offset:256 nt
    s_add_u32 s88, s87, 6144
    buffer_load_dwordx4 v[88:91], v2, s[32:35], s88 offen offset:0 nt
    buffer_load_dwordx4 v[92:95], v2, s[32:35], s88 offen offset:128 nt
    buffer_load_dwordx4 v[96:99], v2, s[32:35], s88 offen offset:256 nt
    s_add_u32 s88, s87, 9216
    buffer_load_dwordx4 v[100:103], v2, s[32:35], s88 offen offset:0 nt
    buffer_load_dwordx4 v[104:107], v2, s[32:35], s88 offen offset:128 nt
    buffer_load_dwordx4 v[108:111], v2, s[32:35], s88 offen offset:256 nt
    s_add_u32 s88, s87, 12288
    buffer_load_dwordx4 v[112:115], v2, s[32:35], s88 offen offset:0 nt
    buffer_load_dwordx4 v[116:119], v2, s[32:35], s88 offen offset:128 nt
    buffer_load_dwordx4 v[120:123], v2, s[32:35], s88 offen offset:256 nt
    s_add_u32 s88, s87, 15360
    buffer_load_dwordx4 v[124:127], v2, s[32:35], s88 offen offset:0 nt
    buffer_load_dwordx4 v[128:131], v2, s[32:35], s88 offen offset:128 nt
    buffer_load_dwordx4 v[132:135], v2, s[32:35], s88 offen offset:256 nt
    s_add_u32 s88, s87, 18432
    buffer_load_dwordx4 v[136:139], v2, s[32:35], s88 offen offset:0 nt
    buffer_load_dwordx4 v[140:143], v2, s[32:35], s88 offen offset:128 nt
    buffer_load_dwordx4 v[144:147], v2, s[32:35], s88 offen offset:256 nt
    s_add_u32 s88, s87, 21504
    buffer_load_dwordx4 v[148:151], v2, s[32:35], s88 offen offset:0 nt
    buffer_load_dwordx4 v[152:155], v2, s[32:35], s88 offen offset:128 nt
    buffer_load_dwordx4 v[156:159], v2, s[32:35], s88 offen offset:256 nt
    s_add_u32 s88, s87, 24576
    buffer_load_dwordx4 v[160:163], v2, s[32:35], s88 offen offset:0 nt
    buffer_load_dwordx4 v[164:167], v2, s[32:35], s88 offen offset:128 nt
    buffer_load_dwordx4 v[168:171], v2, s[32:35], s88 offen offset:256 nt
    s_add_u32 s88, s87, 27648
    buffer_load_dwordx4 v[172:175], v2, s[32:35], s88 offen offset:0 nt
    buffer_load_dwordx4 v[176:179], v2, s[32:35], s88 offen offset:128 nt
    buffer_load_dwordx4 v[180:183], v2, s[32:35], s88 offen offset:256 nt
    s_add_u32 s88, s87, 30720
    buffer_load_dwordx4 v[184:187], v2, s[32:35], s88 offen offset:0 nt
    buffer_load_dwordx4 v[188:191], v2, s[32:35], s88 offen offset:128 nt
    buffer_load_dwordx4 v[192:195], v2, s[32:35], s88 offen offset:256 nt
    s_add_u32 s88, s87, 33792
    buffer_load_dwordx4 v[196:199], v2, s[32:35], s88 offen offset:0 nt
    buffer_load_dwordx4 v[200:203], v2, s[32:35], s88 offen offset:128 nt
    buffer_load_dwordx4 v[204:207], v2, s[32:35], s88 offen offset:256 nt
    s_add_u32 s88, s87, 36864
    buffer_load_dwordx4 v[208:211], v2, s[32:35], s88 offen offset:0 nt
    buffer_load_dwordx4 v[212:215], v2, s[32:35], s88 offen offset:128 nt
    buffer_load_dwordx4 v[216:219], v2, s[32:35], s88 offen offset:256 nt
    s_add_u32 s88, s87, 39936
    buffer_load_dwordx4 v[220:223], v2, s[32:35], s88 offen offset:0 nt
    buffer_load_dwordx4 v[224:227], v2, s[32:35], s88 offen offset:128 nt
    buffer_load_dwordx4 v[228:231], v2, s[32:35], s88 offen offset:256 nt
    s_add_u32 s88, s87, 43008
    buffer_load_dwordx4 v[232:235], v2, s[32:35], s88 offen offset:0 nt
    buffer_load_dwordx4 v[236:239], v2, s[32:35], s88 offen offset:128 nt
    buffer_load_dwordx4 v[240:243], v2, s[32:35], s88 offen offset:256 nt
    s_add_u32 s88, s87, 46080
    buffer_load_dwordx4 v[244:247], v2, s[32:35], s88 offen offset:0 nt
    buffer_load_dwordx4 v[248:251], v2, s[32:35], s88 offen offset:128 nt
    buffer_load_dwordx4 v[252:255], v2, s[32:35], s88 offen offset:256 nt
L_k0done:
    s_nop 3
    v_and_b32 v4, 7, v1
    v_lshlrev_b32 v4, 4, v4
    ds_read_b128 v[32:35], v4 offset:9216
    ds_read_b128 v[36:39], v4 offset:9344
    ds_read_b128 v[40:43], v4 offset:9472
    s_waitcnt lgkmcnt(0)
    v_mov_b32 v4, 0
    v_mov_b32 v5, 0
    v_mov_b32 v6, 0
    s_waitcnt vmcnt(47)
    v_dot2c_f32_bf16 v4, v64, v32
    v_dot2c_f32_bf16 v4, v65, v33
    v_dot2c_f32_bf16 v4, v66, v34
    v_dot2c_f32_bf16 v4, v67, v35
    s_waitcnt vmcnt(46)
    v_dot2c_f32_bf16 v5, v68, v36
    v_dot2c_f32_bf16 v5, v69, v37
    v_dot2c_f32_bf16 v5, v70, v38
    v_dot2c_f32_bf16 v5, v71, v39
    s_waitcnt vmcnt(45)
    v_dot2c_f32_bf16 v6, v72, v40
    v_dot2c_f32_bf16 v6, v73, v41
    v_dot2c_f32_bf16 v6, v74, v42
    v_dot2c_f32_bf16 v6, v75, v43
    s_add_u32 s88, s87, 0
    buffer_load_dwordx4 v[64:67], v2, s[36:39], s88 offen offset:0 nt
    buffer_load_dwordx4 v[68:71], v2, s[36:39], s88 offen offset:128 nt
    buffer_load_dwordx4 v[72:75], v2, s[36:39], s88 offen offset:256 nt
    v_mov_b32 v60, 0
    v_mov_b32 v61, 0
    v_mov_b32 v62, 0
    s_waitcnt vmcnt(47)
    v_dot2c_f32_bf16 v60, v76, v32
    v_dot2c_f32_bf16 v60, v77, v33
    v_dot2c_f32_bf16 v60, v78, v34
    v_dot2c_f32_bf16 v60, v79, v35
    s_waitcnt vmcnt(46)
    v_dot2c_f32_bf16 v61, v80, v36
    v_dot2c_f32_bf16 v61, v81, v37
    v_dot2c_f32_bf16 v61, v82, v38
    v_dot2c_f32_bf16 v61, v83, v39
    s_waitcnt vmcnt(45)
    v_dot2c_f32_bf16 v62, v84, v40
    v_dot2c_f32_bf16 v62, v85, v41
    v_dot2c_f32_bf16 v62, v86, v42
    v_dot2c_f32_bf16 v62, v87, v43
    s_add_u32 s88, s87, 3072
    buffer_load_dwordx4 v[76:79], v2, s[36:39], s88 offen offset:0 nt
    buffer_load_dwordx4 v[80:83], v2, s[36:39], s88 offen offset:128 nt
    buffer_load_dwordx4 v[84:87], v2, s[36:39], s88 offen offset:256 nt
    v_add_f32 v44, v4, v5
    v_add_f32 v44, v44, v6
    v_mov_b32 v4, 0
    v_mov_b32 v5, 0
    v_mov_b32 v6, 0
    s_waitcnt vmcnt(47)
    v_dot2c_f32_bf16 v4, v88, v32
    v_dot2c_f32_bf16 v4, v89, v33
    v_dot2c_f32_bf16 v4, v90, v34
    v_dot2c_f32_bf16 v4, v91, v35
    s_waitcnt vmcnt(46)
    v_dot2c_f32_bf16 v5, v92, v36
    v_dot2c_f32_bf16 v5, v93, v37
    v_dot2c_f32_bf16 v5, v94, v38
    v_dot2c_f32_bf16 v5, v95, v39
    s_waitcnt vmcnt(45)
    v_dot2c_f32_bf16 v6, v96, v40
    v_dot2c_f32_bf16 v6, v97, v41
    v_dot2c_f32_bf16 v6, v98, v42
    v_dot2c_f32_bf16 v6, v99, v43
    s_add_u32 s88, s87, 6144
    buffer_load_dwordx4 v[88:91], v2, s[36:39], s88 offen offset:0 nt
    buffer_load_dwordx4 v[92:95], v2, s[36:39], s88 offen offset:128 nt
    buffer_load_dwordx4 v[96:99], v2, s[36:39], s88 offen offset:256 nt
    v_add_f32 v45, v60, v61
    v_add_f32 v45, v45, v62
    v_mov_b32 v60, 0
    v_mov_b32 v61, 0
    v_mov_b32 v62, 0
    s_waitcnt vmcnt(47)
    v_dot2c_f32_bf16 v60, v100, v32
    v_dot2c_f32_bf16 v60, v101, v33
    v_dot2c_f32_bf16 v60, v102, v34
    v_dot2c_f32_bf16 v60, v103, v35
    s_waitcnt vmcnt(46)
    v_dot2c_f32_bf16 v61, v104, v36
    v_dot2c_f32_bf16 v61, v105, v37
    v_dot2c_f32_bf16 v61, v106, v38
    v_dot2c_f32_bf16 v61, v107, v39
    s_waitcnt vmcnt(45)
    v_dot2c_f32_bf16 v62, v108, v40
    v_dot2c_f32_bf16 v62, v109, v41
    v_dot2c_f32_bf16 v62, v110, v42
    v_dot2c_f32_bf16 v62, v111, v43
    v_add_f32 v46, v4, v5
    v_add_f32 v46, v46, v6
    v_mov_b32 v4, 0
    v_mov_b32 v5, 0
    v_mov_b32 v6, 0
    s_waitcnt vmcnt(44)
    v_dot2c_f32_bf16 v4, v112, v32
    v_dot2c_f32_bf16 v4, v113, v33
    v_dot2c_f32_bf16 v4, v114, v34
    v_dot2c_f32_bf16 v4, v115, v35
    s_waitcnt vmcnt(43)
    v_dot2c_f32_bf16 v5, v116, v36
    v_dot2c_f32_bf16 v5, v117, v37
    v_dot2c_f32_bf16 v5, v118, v38
    v_dot2c_f32_bf16 v5, v119, v39
    s_waitcnt vmcnt(42)
    v_dot2c_f32_bf16 v6, v120, v40
    v_dot2c_f32_bf16 v6, v121, v41
    v_dot2c_f32_bf16 v6, v122, v42
    v_dot2c_f32_bf16 v6, v123, v43
    v_add_f32 v47, v60, v61
    v_add_f32 v47, v47, v62
    v_mov_b32 v60, 0
    v_mov_b32 v61, 0
    v_mov_b32 v62, 0
    s_waitcnt vmcnt(41)
    v_dot2c_f32_bf16 v60, v124, v32
    v_dot2c_f32_bf16 v60, v125, v33
    v_dot2c_f32_bf16 v60, v126, v34
    v_dot2c_f32_bf16 v60, v127, v35
    s_waitcnt vmcnt(40)
    v_dot2c_f32_bf16 v61, v128, v36
    v_dot2c_f32_bf16 v61, v129, v37
    v_dot2c_f32_bf16 v61, v130, v38
    v_dot2c_f32_bf16 v61, v131, v39
    s_waitcnt vmcnt(39)
    v_dot2c_f32_bf16 v62, v132, v40
    v_dot2c_f32_bf16 v62, v133, v41
    v_dot2c_f32_bf16 v62, v134, v42
    v_dot2c_f32_bf16 v62, v135, v43
    v_add_f32 v48, v4, v5
    v_add_f32 v48, v48, v6
    v_mov_b32 v4, 0
    v_mov_b32 v5, 0
    v_mov_b32 v6, 0
    s_waitcnt vmcnt(38)
    v_dot2c_f32_bf16 v4, v136, v32
    v_dot2c_f32_bf16 v4, v137, v33
    v_dot2c_f32_bf16 v4, v138, v34
    v_dot2c_f32_bf16 v4, v139, v35
    s_waitcnt vmcnt(37)
    v_dot2c_f32_bf16 v5, v140, v36
    v_dot2c_f32_bf16 v5, v141, v37
    v_dot2c_f32_bf16 v5, v142, v38
    v_dot2c_f32_bf16 v5, v143, v39
    s_waitcnt vmcnt(36)
    v_dot2c_f32_bf16 v6, v144, v40
    v_dot2c_f32_bf16 v6, v145, v41
    v_dot2c_f32_bf16 v6, v146, v42
    v_dot2c_f32_bf16 v6, v147, v43
    v_add_f32 v49, v60, v61
    v_add_f32 v49, v49, v62
    v_mov_b32 v60, 0
    v_mov_b32 v61, 0
    v_mov_b32 v62, 0
    s_waitcnt vmcnt(35)
    v_dot2c_f32_bf16 v60, v148, v32
    v_dot2c_f32_bf16 v60, v149, v33
    v_dot2c_f32_bf16 v60, v150, v34
    v_dot2c_f32_bf16 v60, v151, v35
    s_waitcnt vmcnt(34)
    v_dot2c_f32_bf16 v61, v152, v36
    v_dot2c_f32_bf16 v61, v153, v37
    v_dot2c_f32_bf16 v61, v154, v38
    v_dot2c_f32_bf16 v61, v155, v39
    s_waitcnt vmcnt(33)
    v_dot2c_f32_bf16 v62, v156, v40
    v_dot2c_f32_bf16 v62, v157, v41
    v_dot2c_f32_bf16 v62, v158, v42
    v_dot2c_f32_bf16 v62, v159, v43
    v_add_f32 v50, v4, v5
    v_add_f32 v50, v50, v6
    v_mov_b32 v4, 0
    v_mov_b32 v5, 0
    v_mov_b32 v6, 0
    s_waitcnt vmcnt(32)
    v_dot2c_f32_bf16 v4, v160, v32
    v_dot2c_f32_bf16 v4, v161, v33
    v_dot2c_f32_bf16 v4, v162, v34
    v_dot2c_f32_bf16 v4, v163, v35
    s_waitcnt vmcnt(31)
    v_dot2c_f32_bf16 v5, v164, v36
    v_dot2c_f32_bf16 v5, v165, v37
    v_dot2c_f32_bf16 v5, v166, v38
    v_dot2c_f32_bf16 v5, v167, v39
    s_waitcnt vmcnt(30)
    v_dot2c_f32_bf16 v6, v168, v40
    v_dot2c_f32_bf16 v6, v169, v41
    v_dot2c_f32_bf16 v6, v170, v42
    v_dot2c_f32_bf16 v6, v171, v43
    v_add_f32 v51, v60, v61
    v_add_f32 v51, v51, v62
    v_mov_b32 v60, 0
    v_mov_b32 v61, 0
    v_mov_b32 v62, 0
    s_waitcnt vmcnt(29)
    v_dot2c_f32_bf16 v60, v172, v32
    v_dot2c_f32_bf16 v60, v173, v33
    v_dot2c_f32_bf16 v60, v174, v34
    v_dot2c_f32_bf16 v60, v175, v35
    s_waitcnt vmcnt(28)
    v_dot2c_f32_bf16 v61, v176, v36
    v_dot2c_f32_bf16 v61, v177, v37
    v_dot2c_f32_bf16 v61, v178, v38
    v_dot2c_f32_bf16 v61, v179, v39
    s_waitcnt vmcnt(27)
    v_dot2c_f32_bf16 v62, v180, v40
    v_dot2c_f32_bf16 v62, v181, v41
    v_dot2c_f32_bf16 v62, v182, v42
    v_dot2c_f32_bf16 v62, v183, v43
    v_add_f32 v52, v4, v5
    v_add_f32 v52, v52, v6
    v_mov_b32 v4, 0
    v_mov_b32 v5, 0
    v_mov_b32 v6, 0
    s_waitcnt vmcnt(26)
    v_dot2c_f32_bf16 v4, v184, v32
    v_dot2c_f32_bf16 v4, v185, v33
    v_dot2c_f32_bf16 v4, v186, v34
    v_dot2c_f32_bf16 v4, v187, v35
    s_waitcnt vmcnt(25)
    v_dot2c_f32_bf16 v5, v188, v36
    v_dot2c_f32_bf16 v5, v189, v37
    v_dot2c_f32_bf16 v5, v190, v38
    v_dot2c_f32_bf16 v5, v191, v39
    s_waitcnt vmcnt(24)
    v_dot2c_f32_bf16 v6, v192, v40
    v_dot2c_f32_bf16 v6, v193, v41
    v_dot2c_f32_bf16 v6, v194, v42
    v_dot2c_f32_bf16 v6, v195, v43
    v_add_f32 v53, v60, v61
    v_add_f32 v53, v53, v62
    v_mov_b32 v60, 0
    v_mov_b32 v61, 0
    v_mov_b32 v62, 0
    s_waitcnt vmcnt(23)
    v_dot2c_f32_bf16 v60, v196, v32
    v_dot2c_f32_bf16 v60, v197, v33
    v_dot2c_f32_bf16 v60, v198, v34
    v_dot2c_f32_bf16 v60, v199, v35
    s_waitcnt vmcnt(22)
    v_dot2c_f32_bf16 v61, v200, v36
    v_dot2c_f32_bf16 v61, v201, v37
    v_dot2c_f32_bf16 v61, v202, v38
    v_dot2c_f32_bf16 v61, v203, v39
    s_waitcnt vmcnt(21)
    v_dot2c_f32_bf16 v62, v204, v40
    v_dot2c_f32_bf16 v62, v205, v41
    v_dot2c_f32_bf16 v62, v206, v42
    v_dot2c_f32_bf16 v62, v207, v43
    v_add_f32 v54, v4, v5
    v_add_f32 v54, v54, v6
    v_mov_b32 v4, 0
    v_mov_b32 v5, 0
    v_mov_b32 v6, 0
    s_waitcnt vmcnt(20)
    v_dot2c_f32_bf16 v4, v208, v32
    v_dot2c_f32_bf16 v4, v209, v33
    v_dot2c_f32_bf16 v4, v210, v34
    v_dot2c_f32_bf16 v4, v211, v35
    s_waitcnt vmcnt(19)
    v_dot2c_f32_bf16 v5, v212, v36
    v_dot2c_f32_bf16 v5, v213, v37
    v_dot2c_f32_bf16 v5, v214, v38
    v_dot2c_f32_bf16 v5, v215, v39
    s_waitcnt vmcnt(18)
    v_dot2c_f32_bf16 v6, v216, v40
    v_dot2c_f32_bf16 v6, v217, v41
    v_dot2c_f32_bf16 v6, v218, v42
    v_dot2c_f32_bf16 v6, v219, v43
    v_add_f32 v55, v60, v61
    v_add_f32 v55, v55, v62
    v_mov_b32 v60, 0
    v_mov_b32 v61, 0
    v_mov_b32 v62, 0
    s_waitcnt vmcnt(17)
    v_dot2c_f32_bf16 v60, v220, v32
    v_dot2c_f32_bf16 v60, v221, v33
    v_dot2c_f32_bf16 v60, v222, v34
    v_dot2c_f32_bf16 v60, v223, v35
    s_waitcnt vmcnt(16)
    v_dot2c_f32_bf16 v61, v224, v36
    v_dot2c_f32_bf16 v61, v225, v37
    v_dot2c_f32_bf16 v61, v226, v38
    v_dot2c_f32_bf16 v61, v227, v39
    s_waitcnt vmcnt(15)
    v_dot2c_f32_bf16 v62, v228, v40
    v_dot2c_f32_bf16 v62, v229, v41
    v_dot2c_f32_bf16 v62, v230, v42
    v_dot2c_f32_bf16 v62, v231, v43
    v_add_f32 v56, v4, v5
    v_add_f32 v56, v56, v6
    v_mov_b32 v4, 0
    v_mov_b32 v5, 0
    v_mov_b32 v6, 0
    s_waitcnt vmcnt(14)
    v_dot2c_f32_bf16 v4, v232, v32
    v_dot2c_f32_bf16 v4, v233, v33
    v_dot2c_f32_bf16 v4, v234, v34
    v_dot2c_f32_bf16 v4, v235, v35
    s_waitcnt vmcnt(13)
    v_dot2c_f32_bf16 v5, v236, v36
    v_dot2c_f32_bf16 v5, v237, v37
    v_dot2c_f32_bf16 v5, v238, v38
    v_dot2c_f32_bf16 v5, v239, v39
    s_waitcnt vmcnt(12)
    v_dot2c_f32_bf16 v6, v240, v40
    v_dot2c_f32_bf16 v6, v241, v41
    v_dot2c_f32_bf16 v6, v242, v42
    v_dot2c_f32_bf16 v6, v243, v43
    v_add_f32 v57, v60, v61
    v_add_f32 v57, v57, v62
    v_mov_b32 v60, 0
    v_mov_b32 v61, 0
    v_mov_b32 v62, 0
    s_waitcnt vmcnt(11)
    v_dot2c_f32_bf16 v60, v244, v32
    v_dot2c_f32_bf16 v60, v245, v33
    v_dot2c_f32_bf16 v60, v246, v34
    v_dot2c_f32_bf16 v60, v247, v35
    s_waitcnt vmcnt(10)
    v_dot2c_f32_bf16 v61, v248, v36
    v_dot2c_f32_bf16 v61, v249, v37
    v_dot2c_f32_bf16 v61, v250, v38
    v_dot2c_f32_bf16 v61, v251, v39
    s_waitcnt vmcnt(9)
    v_dot2c_f32_bf16 v62, v252, v40
    v_dot2c_f32_bf16 v62, v253, v41
    v_dot2c_f32_bf16 v62, v254, v42
    v_dot2c_f32_bf16 v62, v255, v43
    v_add_f32 v58, v4, v5
    v_add_f32 v58, v58, v6
    v_add_f32 v59, v60, v61
    v_add_f32 v59, v59, v62
    v_add_f32_dpp v44, v44, v44 quad_perm:[1,0,3,2] row_mask:0xf bank_mask:0xf
    v_add_f32_dpp v45, v45, v45 quad_perm:[1,0,3,2] row_mask:0xf bank_mask:0xf
    v_add_f32_dpp v46, v46, v46 quad_perm:[1,0,3,2] row_mask:0xf bank_mask:0xf
    v_add_f32_dpp v47, v47, v47 quad_perm:[1,0,3,2] row_mask:0xf bank_mask:0xf
    v_add_f32_dpp v48, v48, v48 quad_perm:[1,0,3,2] row_mask:0xf bank_mask:0xf
    v_add_f32_dpp v49, v49, v49 quad_perm:[1,0,3,2] row_mask:0xf bank_mask:0xf
    v_add_f32_dpp v50, v50, v50 quad_perm:[1,0,3,2] row_mask:0xf bank_mask:0xf
    v_add_f32_dpp v51, v51, v51 quad_perm:[1,0,3,2] row_mask:0xf bank_mask:0xf
    v_add_f32_dpp v52, v52, v52 quad_perm:[1,0,3,2] row_mask:0xf bank_mask:0xf
    v_add_f32_dpp v53, v53, v53 quad_perm:[1,0,3,2] row_mask:0xf bank_mask:0xf
    v_add_f32_dpp v54, v54, v54 quad_perm:[1,0,3,2] row_mask:0xf bank_mask:0xf
    v_add_f32_dpp v55, v55, v55 quad_perm:[1,0,3,2] row_mask:0xf bank_mask:0xf
    v_add_f32_dpp v56, v56, v56 quad_perm:[1,0,3,2] row_mask:0xf bank_mask:0xf
    v_add_f32_dpp v57, v57, v57 quad_perm:[1,0,3,2] row_mask:0xf bank_mask:0xf
    v_add_f32_dpp v58, v58, v58 quad_perm:[1,0,3,2] row_mask:0xf bank_mask:0xf
    v_add_f32_dpp v59, v59, v59 quad_perm:[1,0,3,2] row_mask:0xf bank_mask:0xf
    v_add_f32_dpp v44, v44, v44 quad_perm:[2,3,0,1] row_mask:0xf bank_mask:0xf
    v_add_f32_dpp v45, v45, v45 quad_perm:[2,3,0,1] row_mask:0xf bank_mask:0xf
    v_add_f32_dpp v46, v46, v46 quad_perm:[2,3,0,1] row_mask:0xf bank_mask:0xf
    v_add_f32_dpp v47, v47, v47 quad_perm:[2,3,0,1] row_mask:0xf bank_mask:0xf
    v_add_f32_dpp v48, v48, v48 quad_perm:[2,3,0,1] row_mask:0xf bank_mask:0xf
    v_add_f32_dpp v49, v49, v49 quad_perm:[2,3,0,1] row_mask:0xf bank_mask:0xf
    v_add_f32_dpp v50, v50, v50 quad_perm:[2,3,0,1] row_mask:0xf bank_mask:0xf
    v_add_f32_dpp v51, v51, v51 quad_perm:[2,3,0,1] row_mask:0xf bank_mask:0xf
    v_add_f32_dpp v52, v52, v52 quad_perm:[2,3,0,1] row_mask:0xf bank_mask:0xf
    v_add_f32_dpp v53, v53, v53 quad_perm:[2,3,0,1] row_mask:0xf bank_mask:0xf
    v_add_f32_dpp v54, v54, v54 quad_perm:[2,3,0,1] row_mask:0xf bank_mask:0xf
    v_add_f32_dpp v55, v55, v55 quad_perm:[2,3,0,1] row_mask:0xf bank_mask:0xf
    v_add_f32_dpp v56, v56, v56 quad_perm:[2,3,0,1] row_mask:0xf bank_mask:0xf
    v_add_f32_dpp v57, v57, v57 quad_perm:[2,3,0,1] row_mask:0xf bank_mask:0xf
    v_add_f32_dpp v58, v58, v58 quad_perm:[2,3,0,1] row_mask:0xf bank_mask:0xf
    v_add_f32_dpp v59, v59, v59 quad_perm:[2,3,0,1] row_mask:0xf bank_mask:0xf
    v_add_f32_dpp v44, v44, v44 row_half_mirror row_mask:0xf bank_mask:0xf
    v_add_f32_dpp v45, v45, v45 row_half_mirror row_mask:0xf bank_mask:0xf
    v_add_f32_dpp v46, v46, v46 row_half_mirror row_mask:0xf bank_mask:0xf
    v_add_f32_dpp v47, v47, v47 row_half_mirror row_mask:0xf bank_mask:0xf
    v_add_f32_dpp v48, v48, v48 row_half_mirror row_mask:0xf bank_mask:0xf
    v_add_f32_dpp v49, v49, v49 row_half_mirror row_mask:0xf bank_mask:0xf
    v_add_f32_dpp v50, v50, v50 row_half_mirror row_mask:0xf bank_mask:0xf
    v_add_f32_dpp v51, v51, v51 row_half_mirror row_mask:0xf bank_mask:0xf
    v_add_f32_dpp v52, v52, v52 row_half_mirror row_mask:0xf bank_mask:0xf
    v_add_f32_dpp v53, v53, v53 row_half_mirror row_mask:0xf bank_mask:0xf
    v_add_f32_dpp v54, v54, v54 row_half_mirror row_mask:0xf bank_mask:0xf
    v_add_f32_dpp v55, v55, v55 row_half_mirror row_mask:0xf bank_mask:0xf
    v_add_f32_dpp v56, v56, v56 row_half_mirror row_mask:0xf bank_mask:0xf
    v_add_f32_dpp v57, v57, v57 row_half_mirror row_mask:0xf bank_mask:0xf
    v_add_f32_dpp v58, v58, v58 row_half_mirror row_mask:0xf bank_mask:0xf
    v_add_f32_dpp v59, v59, v59 row_half_mirror row_mask:0xf bank_mask:0xf
    s_mov_b32 s90, 0x3d93cd3a
    v_cvt_pk_bf16_f32 v32, v44, v45
    v_lshlrev_b32 v44, 16, v32
    v_and_b32 v45, s89, v32
    v_cvt_pk_bf16_f32 v33, v46, v47
    v_lshlrev_b32 v46, 16, v33
    v_and_b32 v47, s89, v33
    v_cvt_pk_bf16_f32 v34, v48, v49
    v_lshlrev_b32 v48, 16, v34
    v_and_b32 v49, s89, v34
    v_cvt_pk_bf16_f32 v35, v50, v51
    v_lshlrev_b32 v50, 16, v35
    v_and_b32 v51, s89, v35
    v_cvt_pk_bf16_f32 v36, v52, v53
    v_lshlrev_b32 v52, 16, v36
    v_and_b32 v53, s89, v36
    v_cvt_pk_bf16_f32 v37, v54, v55
    v_lshlrev_b32 v54, 16, v37
    v_and_b32 v55, s89, v37
    v_cvt_pk_bf16_f32 v38, v56, v57
    v_lshlrev_b32 v56, 16, v38
    v_and_b32 v57, s89, v38
    v_cvt_pk_bf16_f32 v39, v58, v59
    v_lshlrev_b32 v58, 16, v39
    v_and_b32 v59, s89, v39
    v_mul_f32 v44, s90, v44
    v_mul_f32 v45, s90, v45
    v_mul_f32 v46, s90, v46
    v_mul_f32 v47, s90, v47
    v_mul_f32 v48, s90, v48
    v_mul_f32 v49, s90, v49
    v_mul_f32 v50, s90, v50
    v_mul_f32 v51, s90, v51
    v_mul_f32 v52, s90, v52
    v_mul_f32 v53, s90, v53
    v_mul_f32 v54, s90, v54
    v_mul_f32 v55, s90, v55
    v_mul_f32 v56, s90, v56
    v_mul_f32 v57, s90, v57
    v_mul_f32 v58, s90, v58
    v_mul_f32 v59, s90, v59
    v_cvt_pk_bf16_f32 v32, v44, v45
    v_lshlrev_b32 v44, 16, v32
    v_and_b32 v45, s89, v32
    v_cvt_pk_bf16_f32 v33, v46, v47
    v_lshlrev_b32 v46, 16, v33
    v_and_b32 v47, s89, v33
    v_cvt_pk_bf16_f32 v34, v48, v49
    v_lshlrev_b32 v48, 16, v34
    v_and_b32 v49, s89, v34
    v_cvt_pk_bf16_f32 v35, v50, v51
    v_lshlrev_b32 v50, 16, v35
    v_and_b32 v51, s89, v35
    v_cvt_pk_bf16_f32 v36, v52, v53
    v_lshlrev_b32 v52, 16, v36
    v_and_b32 v53, s89, v36
    v_cvt_pk_bf16_f32 v37, v54, v55
    v_lshlrev_b32 v54, 16, v37
    v_and_b32 v55, s89, v37
    v_cvt_pk_bf16_f32 v38, v56, v57
    v_lshlrev_b32 v56, 16, v38
    v_and_b32 v57, s89, v38
    v_cvt_pk_bf16_f32 v39, v58, v59
    v_lshlrev_b32 v58, 16, v39
    v_and_b32 v59, s89, v39
    v_max3_f32 v32, v44, v45, v46
    v_max3_f32 v33, v47, v48, v49
    v_max3_f32 v34, v50, v51, v52
    v_max3_f32 v35, v53, v54, v55
    v_max3_f32 v36, v56, v57, v58
    v_max3_f32 v32, v32, v33, v59
    v_max3_f32 v34, v34, v35, v36
    v_max_f32 v32, v32, v34
    s_nop 1
    v_max_f32_dpp v32, v32, v32 row_ror:8 row_mask:0xf bank_mask:0xf
    v_mov_b32 v33, v32
    s_nop 1
    v_permlane16_swap_b32 v32, v33
    v_max_f32 v32, v32, v33
    v_mov_b32 v33, v32
    s_nop 1
    v_permlane32_swap_b32 v32, v33
    v_max_f32 v6, v32, v33
    s_mov_b32 s90, 0x3fb8aa3b
    v_mul_f32 v33, s90, v6
    v_fma_f32 v44, v44, s90, -v33
    v_fma_f32 v45, v45, s90, -v33
    v_fma_f32 v46, v46, s90, -v33
    v_fma_f32 v47, v47, s90, -v33
    v_fma_f32 v48, v48, s90, -v33
    v_fma_f32 v49, v49, s90, -v33
    v_fma_f32 v50, v50, s90, -v33
    v_fma_f32 v51, v51, s90, -v33
    v_fma_f32 v52, v52, s90, -v33
    v_fma_f32 v53, v53, s90, -v33
    v_fma_f32 v54, v54, s90, -v33
    v_fma_f32 v55, v55, s90, -v33
    v_fma_f32 v56, v56, s90, -v33
    v_fma_f32 v57, v57, s90, -v33
    v_fma_f32 v58, v58, s90, -v33
    v_fma_f32 v59, v59, s90, -v33
    v_exp_f32 v44, v44
    v_exp_f32 v45, v45
    v_exp_f32 v46, v46
    v_exp_f32 v47, v47
    v_exp_f32 v48, v48
    v_exp_f32 v49, v49
    v_exp_f32 v50, v50
    v_exp_f32 v51, v51
    v_exp_f32 v52, v52
    v_exp_f32 v53, v53
    v_exp_f32 v54, v54
    v_exp_f32 v55, v55
    v_exp_f32 v56, v56
    v_exp_f32 v57, v57
    v_exp_f32 v58, v58
    v_exp_f32 v59, v59
    v_add_f32 v32, v44, v45
    v_add_f32 v33, v46, v47
    v_add_f32 v32, v32, v48
    v_add_f32 v33, v33, v49
    v_add_f32 v32, v32, v50
    v_add_f32 v33, v33, v51
    v_add_f32 v32, v32, v52
    v_add_f32 v33, v33, v53
    v_add_f32 v32, v32, v54
    v_add_f32 v33, v33, v55
    v_add_f32 v32, v32, v56
    v_add_f32 v33, v33, v57
    v_add_f32 v32, v32, v58
    v_add_f32 v33, v33, v59
    v_add_f32 v5, v32, v33
    v_mov_b32 v8, 0
    v_mov_b32 v9, 0
    v_mov_b32 v10, 0
    v_mov_b32 v11, 0
    v_mov_b32 v12, 0
    v_mov_b32 v13, 0
    v_mov_b32 v14, 0
    v_mov_b32 v15, 0
    v_mov_b32 v16, 0
    v_mov_b32 v17, 0
    v_mov_b32 v18, 0
    v_mov_b32 v19, 0
    v_mov_b32 v20, 0
    v_mov_b32 v21, 0
    v_mov_b32 v22, 0
    v_mov_b32 v23, 0
    v_mov_b32 v24, 0
    v_mov_b32 v25, 0
    v_mov_b32 v26, 0
    v_mov_b32 v27, 0
    v_mov_b32 v28, 0
    v_mov_b32 v29, 0
    v_mov_b32 v30, 0
    v_mov_b32 v31, 0
    v_mul_u32_u24 v60, 205, v1
    v_lshrrev_b32 v60, 11, v60
    v_mul_u32_u24 v61, 10, v60
    v_sub_u32 v61, v1, v61
    v_mul_u32_u24 v62, 1280, v60
    v_lshlrev_b32 v63, 4, v61
    v_add_u32 v62, v62, v63
    v_mul_u32_u24 v3, 20, v1
    s_mul_i32 s84, s80, 192
    s_mul_i32 s83, s82, 24
    s_add_u32 s84, s84, s83
    s_mul_i32 s84, s84, 1280
    s_mul_i32 s83, s81, 160
    s_add_u32 s84, s84, s83
    s_mul_i32 s85, s80, 48
    s_mul_i32 s86, s82, 6
    s_add_u32 s85, s85, s86
    s_mul_i32 s85, s85, 1280
    s_add_u32 s85, s85, s83
    s_waitcnt vmcnt(6)
    s_add_u32 s88, s87, 9216
    buffer_load_dwordx4 v[100:103], v2, s[36:39], s88 offen offset:0 nt
    buffer_load_dwordx4 v[104:107], v2, s[36:39], s88 offen offset:128 nt
    buffer_load_dwordx4 v[108:111], v2, s[36:39], s88 offen offset:256 nt
    v_lshlrev_b32 v32, 16, v64
    v_and_b32 v33, s89, v64
    v_fmac_f32 v8, v44, v32
    v_fmac_f32 v9, v44, v33
    v_lshlrev_b32 v34, 16, v65
    v_and_b32 v35, s89, v65
    v_fmac_f32 v10, v44, v34
    v_fmac_f32 v11, v44, v35
    v_lshlrev_b32 v36, 16, v66
    v_and_b32 v37, s89, v66
    v_fmac_f32 v12, v44, v36
    v_fmac_f32 v13, v44, v37
    v_lshlrev_b32 v38, 16, v67
    v_and_b32 v39, s89, v67
    v_fmac_f32 v14, v44, v38
    v_fmac_f32 v15, v44, v39
    v_lshlrev_b32 v32, 16, v68
    v_and_b32 v33, s89, v68
    v_fmac_f32 v16, v44, v32
    v_fmac_f32 v17, v44, v33
    v_lshlrev_b32 v34, 16, v69
    v_and_b32 v35, s89, v69
    v_fmac_f32 v18, v44, v34
    v_fmac_f32 v19, v44, v35
    v_lshlrev_b32 v36, 16, v70
    v_and_b32 v37, s89, v70
    v_fmac_f32 v20, v44, v36
    v_fmac_f32 v21, v44, v37
    v_lshlrev_b32 v38, 16, v71
    v_and_b32 v39, s89, v71
    v_fmac_f32 v22, v44, v38
    v_fmac_f32 v23, v44, v39
    v_lshlrev_b32 v32, 16, v72
    v_and_b32 v33, s89, v72
    v_fmac_f32 v24, v44, v32
    v_fmac_f32 v25, v44, v33
    v_lshlrev_b32 v34, 16, v73
    v_and_b32 v35, s89, v73
    v_fmac_f32 v26, v44, v34
    v_fmac_f32 v27, v44, v35
    v_lshlrev_b32 v36, 16, v74
    v_and_b32 v37, s89, v74
    v_fmac_f32 v28, v44, v36
    v_fmac_f32 v29, v44, v37
    v_lshlrev_b32 v38, 16, v75
    v_and_b32 v39, s89, v75
    v_fmac_f32 v30, v44, v38
    v_fmac_f32 v31, v44, v39
    s_waitcnt vmcnt(6)
    s_add_u32 s88, s87, 12288
    buffer_load_dwordx4 v[112:115], v2, s[36:39], s88 offen offset:0 nt
    buffer_load_dwordx4 v[116:119], v2, s[36:39], s88 offen offset:128 nt
    buffer_load_dwordx4 v[120:123], v2, s[36:39], s88 offen offset:256 nt
    v_lshlrev_b32 v32, 16, v76
    v_and_b32 v33, s89, v76
    v_fmac_f32 v8, v45, v32
    v_fmac_f32 v9, v45, v33
    v_lshlrev_b32 v34, 16, v77
    v_and_b32 v35, s89, v77
    v_fmac_f32 v10, v45, v34
    v_fmac_f32 v11, v45, v35
    v_lshlrev_b32 v36, 16, v78
    v_and_b32 v37, s89, v78
    v_fmac_f32 v12, v45, v36
    v_fmac_f32 v13, v45, v37
    v_lshlrev_b32 v38, 16, v79
    v_and_b32 v39, s89, v79
    v_fmac_f32 v14, v45, v38
    v_fmac_f32 v15, v45, v39
    v_lshlrev_b32 v32, 16, v80
    v_and_b32 v33, s89, v80
    v_fmac_f32 v16, v45, v32
    v_fmac_f32 v17, v45, v33
    v_lshlrev_b32 v34, 16, v81
    v_and_b32 v35, s89, v81
    v_fmac_f32 v18, v45, v34
    v_fmac_f32 v19, v45, v35
    v_lshlrev_b32 v36, 16, v82
    v_and_b32 v37, s89, v82
    v_fmac_f32 v20, v45, v36
    v_fmac_f32 v21, v45, v37
    v_lshlrev_b32 v38, 16, v83
    v_and_b32 v39, s89, v83
    v_fmac_f32 v22, v45, v38
    v_fmac_f32 v23, v45, v39
    v_lshlrev_b32 v32, 16, v84
    v_and_b32 v33, s89, v84
    v_fmac_f32 v24, v45, v32
    v_fmac_f32 v25, v45, v33
    v_lshlrev_b32 v34, 16, v85
    v_and_b32 v35, s89, v85
    v_fmac_f32 v26, v45, v34
    v_fmac_f32 v27, v45, v35
    v_lshlrev_b32 v36, 16, v86
    v_and_b32 v37, s89, v86
    v_fmac_f32 v28, v45, v36
    v_fmac_f32 v29, v45, v37
    v_lshlrev_b32 v38, 16, v87
    v_and_b32 v39, s89, v87
    v_fmac_f32 v30, v45, v38
    v_fmac_f32 v31, v45, v39
    s_mov_b32 exec_hi, 0x0fffffff
    buffer_load_dwordx4 v[64:67], v62, s[60:63], s84 offen nt
    s_add_u32 s84, s84, 7680
    buffer_load_dwordx4 v[68:71], v62, s[60:63], s84 offen nt
    s_add_u32 s84, s84, 7680
    buffer_load_dwordx4 v[72:75], v62, s[60:63], s84 offen nt
    s_add_u32 s84, s84, 7680
    buffer_load_dwordx4 v[76:79], v62, s[60:63], s84 offen nt
    buffer_load_dwordx4 v[80:83], v62, s[64:67], s85 offen nt
    s_mov_b64 exec, -1
    s_waitcnt vmcnt(11)
    s_add_u32 s88, s87, 15360
    buffer_load_dwordx4 v[124:127], v2, s[36:39], s88 offen offset:0 nt
    buffer_load_dwordx4 v[128:131], v2, s[36:39], s88 offen offset:128 nt
    buffer_load_dwordx4 v[132:135], v2, s[36:39], s88 offen offset:256 nt
    v_lshlrev_b32 v32, 16, v88
    v_and_b32 v33, s89, v88
    v_fmac_f32 v8, v46, v32
    v_fmac_f32 v9, v46, v33
    v_lshlrev_b32 v34, 16, v89
    v_and_b32 v35, s89, v89
    v_fmac_f32 v10, v46, v34
    v_fmac_f32 v11, v46, v35
    v_lshlrev_b32 v36, 16, v90
    v_and_b32 v37, s89, v90
    v_fmac_f32 v12, v46, v36
    v_fmac_f32 v13, v46, v37
    v_lshlrev_b32 v38, 16, v91
    v_and_b32 v39, s89, v91
    v_fmac_f32 v14, v46, v38
    v_fmac_f32 v15, v46, v39
    v_lshlrev_b32 v32, 16, v92
    v_and_b32 v33, s89, v92
    v_fmac_f32 v16, v46, v32
    v_fmac_f32 v17, v46, v33
    v_lshlrev_b32 v34, 16, v93
    v_and_b32 v35, s89, v93
    v_fmac_f32 v18, v46, v34
    v_fmac_f32 v19, v46, v35
    v_lshlrev_b32 v36, 16, v94
    v_and_b32 v37, s89, v94
    v_fmac_f32 v20, v46, v36
    v_fmac_f32 v21, v46, v37
    v_lshlrev_b32 v38, 16, v95
    v_and_b32 v39, s89, v95
    v_fmac_f32 v22, v46, v38
    v_fmac_f32 v23, v46, v39
    v_lshlrev_b32 v32, 16, v96
    v_and_b32 v33, s89, v96
    v_fmac_f32 v24, v46, v32
    v_fmac_f32 v25, v46, v33
    v_lshlrev_b32 v34, 16, v97
    v_and_b32 v35, s89, v97
    v_fmac_f32 v26, v46, v34
    v_fmac_f32 v27, v46, v35
    v_lshlrev_b32 v36, 16, v98
    v_and_b32 v37, s89, v98
    v_fmac_f32 v28, v46, v36
    v_fmac_f32 v29, v46, v37
    v_lshlrev_b32 v38, 16, v99
    v_and_b32 v39, s89, v99
    v_fmac_f32 v30, v46, v38
    v_fmac_f32 v31, v46, v39
    s_waitcnt vmcnt(11)
    s_add_u32 s88, s87, 18432
    buffer_load_dwordx4 v[136:139], v2, s[36:39], s88 offen offset:0 nt
    buffer_load_dwordx4 v[140:143], v2, s[36:39], s88 offen offset:128 nt
    buffer_load_dwordx4 v[144:147], v2, s[36:39], s88 offen offset:256 nt
    v_lshlrev_b32 v32, 16, v100
    v_and_b32 v33, s89, v100
    v_fmac_f32 v8, v47, v32
    v_fmac_f32 v9, v47, v33
    v_lshlrev_b32 v34, 16, v101
    v_and_b32 v35, s89, v101
    v_fmac_f32 v10, v47, v34
    v_fmac_f32 v11, v47, v35
    v_lshlrev_b32 v36, 16, v102
    v_and_b32 v37, s89, v102
    v_fmac_f32 v12, v47, v36
    v_fmac_f32 v13, v47, v37
    v_lshlrev_b32 v38, 16, v103
    v_and_b32 v39, s89, v103
    v_fmac_f32 v14, v47, v38
    v_fmac_f32 v15, v47, v39
    v_lshlrev_b32 v32, 16, v104
    v_and_b32 v33, s89, v104
    v_fmac_f32 v16, v47, v32
    v_fmac_f32 v17, v47, v33
    v_lshlrev_b32 v34, 16, v105
    v_and_b32 v35, s89, v105
    v_fmac_f32 v18, v47, v34
    v_fmac_f32 v19, v47, v35
    v_lshlrev_b32 v36, 16, v106
    v_and_b32 v37, s89, v106
    v_fmac_f32 v20, v47, v36
    v_fmac_f32 v21, v47, v37
    v_lshlrev_b32 v38, 16, v107
    v_and_b32 v39, s89, v107
    v_fmac_f32 v22, v47, v38
    v_fmac_f32 v23, v47, v39
    v_lshlrev_b32 v32, 16, v108
    v_and_b32 v33, s89, v108
    v_fmac_f32 v24, v47, v32
    v_fmac_f32 v25, v47, v33
    v_lshlrev_b32 v34, 16, v109
    v_and_b32 v35, s89, v109
    v_fmac_f32 v26, v47, v34
    v_fmac_f32 v27, v47, v35
    v_lshlrev_b32 v36, 16, v110
    v_and_b32 v37, s89, v110
    v_fmac_f32 v28, v47, v36
    v_fmac_f32 v29, v47, v37
    v_lshlrev_b32 v38, 16, v111
    v_and_b32 v39, s89, v111
    v_fmac_f32 v30, v47, v38
    v_fmac_f32 v31, v47, v39
    buffer_load_dwordx4 v[88:91], v3, s[44:47], 0 offen
    buffer_load_dword v92, v3, s[44:47], 0 offen offset:16
    buffer_load_dwordx4 v[96:99], v3, s[68:71], 0 offen
    buffer_load_dword v100, v3, s[68:71], 0 offen offset:16
    s_lshl_b32 s90, s80, 2
    v_mov_b32 v101, s90
    buffer_load_dword v102, v101, s[76:79], 0 offen sc0 sc1
    s_waitcnt vmcnt(16)
    s_add_u32 s88, s87, 21504
    buffer_load_dwordx4 v[148:151], v2, s[36:39], s88 offen offset:0 nt
    buffer_load_dwordx4 v[152:155], v2, s[36:39], s88 offen offset:128 nt
    buffer_load_dwordx4 v[156:159], v2, s[36:39], s88 offen offset:256 nt
    v_lshlrev_b32 v32, 16, v112
    v_and_b32 v33, s89, v112
    v_fmac_f32 v8, v48, v32
    v_fmac_f32 v9, v48, v33
    v_lshlrev_b32 v34, 16, v113
    v_and_b32 v35, s89, v113
    v_fmac_f32 v10, v48, v34
    v_fmac_f32 v11, v48, v35
    v_lshlrev_b32 v36, 16, v114
    v_and_b32 v37, s89, v114
    v_fmac_f32 v12, v48, v36
    v_fmac_f32 v13, v48, v37
    v_lshlrev_b32 v38, 16, v115
    v_and_b32 v39, s89, v115
    v_fmac_f32 v14, v48, v38
    v_fmac_f32 v15, v48, v39
    v_lshlrev_b32 v32, 16, v116
    v_and_b32 v33, s89, v116
    v_fmac_f32 v16, v48, v32
    v_fmac_f32 v17, v48, v33
    v_lshlrev_b32 v34, 16, v117
    v_and_b32 v35, s89, v117
    v_fmac_f32 v18, v48, v34
    v_fmac_f32 v19, v48, v35
    v_lshlrev_b32 v36, 16, v118
    v_and_b32 v37, s89, v118
    v_fmac_f32 v20, v48, v36
    v_fmac_f32 v21, v48, v37
    v_lshlrev_b32 v38, 16, v119
    v_and_b32 v39, s89, v119
    v_fmac_f32 v22, v48, v38
    v_fmac_f32 v23, v48, v39
    v_lshlrev_b32 v32, 16, v120
    v_and_b32 v33, s89, v120
    v_fmac_f32 v24, v48, v32
    v_fmac_f32 v25, v48, v33
    v_lshlrev_b32 v34, 16, v121
    v_and_b32 v35, s89, v121
    v_fmac_f32 v26, v48, v34
    v_fmac_f32 v27, v48, v35
    v_lshlrev_b32 v36, 16, v122
    v_and_b32 v37, s89, v122
    v_fmac_f32 v28, v48, v36
    v_fmac_f32 v29, v48, v37
    v_lshlrev_b32 v38, 16, v123
    v_and_b32 v39, s89, v123
    v_fmac_f32 v30, v48, v38
    v_fmac_f32 v31, v48, v39
    s_waitcnt vmcnt(11)
    s_add_u32 s88, s87, 24576
    buffer_load_dwordx4 v[160:163], v2, s[36:39], s88 offen offset:0 nt
    buffer_load_dwordx4 v[164:167], v2, s[36:39], s88 offen offset:128 nt
    buffer_load_dwordx4 v[168:171], v2, s[36:39], s88 offen offset:256 nt
    v_lshlrev_b32 v32, 16, v124
    v_and_b32 v33, s89, v124
    v_fmac_f32 v8, v49, v32
    v_fmac_f32 v9, v49, v33
    v_lshlrev_b32 v34, 16, v125
    v_and_b32 v35, s89, v125
    v_fmac_f32 v10, v49, v34
    v_fmac_f32 v11, v49, v35
    v_lshlrev_b32 v36, 16, v126
    v_and_b32 v37, s89, v126
    v_fmac_f32 v12, v49, v36
    v_fmac_f32 v13, v49, v37
    v_lshlrev_b32 v38, 16, v127
    v_and_b32 v39, s89, v127
    v_fmac_f32 v14, v49, v38
    v_fmac_f32 v15, v49, v39
    v_lshlrev_b32 v32, 16, v128
    v_and_b32 v33, s89, v128
    v_fmac_f32 v16, v49, v32
    v_fmac_f32 v17, v49, v33
    v_lshlrev_b32 v34, 16, v129
    v_and_b32 v35, s89, v129
    v_fmac_f32 v18, v49, v34
    v_fmac_f32 v19, v49, v35
    v_lshlrev_b32 v36, 16, v130
    v_and_b32 v37, s89, v130
    v_fmac_f32 v20, v49, v36
    v_fmac_f32 v21, v49, v37
    v_lshlrev_b32 v38, 16, v131
    v_and_b32 v39, s89, v131
    v_fmac_f32 v22, v49, v38
    v_fmac_f32 v23, v49, v39
    v_lshlrev_b32 v32, 16, v132
    v_and_b32 v33, s89, v132
    v_fmac_f32 v24, v49, v32
    v_fmac_f32 v25, v49, v33
    v_lshlrev_b32 v34, 16, v133
    v_and_b32 v35, s89, v133
    v_fmac_f32 v26, v49, v34
    v_fmac_f32 v27, v49, v35
    v_lshlrev_b32 v36, 16, v134
    v_and_b32 v37, s89, v134
    v_fmac_f32 v28, v49, v36
    v_fmac_f32 v29, v49, v37
    v_lshlrev_b32 v38, 16, v135
    v_and_b32 v39, s89, v135
    v_fmac_f32 v30, v49, v38
    v_fmac_f32 v31, v49, v39
    s_waitcnt vmcnt(11)
    s_add_u32 s88, s87, 27648
    buffer_load_dwordx4 v[172:175], v2, s[36:39], s88 offen offset:0 nt
    buffer_load_dwordx4 v[176:179], v2, s[36:39], s88 offen offset:128 nt
    buffer_load_dwordx4 v[180:183], v2, s[36:39], s88 offen offset:256 nt
    v_lshlrev_b32 v32, 16, v136
    v_and_b32 v33, s89, v136
    v_fmac_f32 v8, v50, v32
    v_fmac_f32 v9, v50, v33
    v_lshlrev_b32 v34, 16, v137
    v_and_b32 v35, s89, v137
    v_fmac_f32 v10, v50, v34
    v_fmac_f32 v11, v50, v35
    v_lshlrev_b32 v36, 16, v138
    v_and_b32 v37, s89, v138
    v_fmac_f32 v12, v50, v36
    v_fmac_f32 v13, v50, v37
    v_lshlrev_b32 v38, 16, v139
    v_and_b32 v39, s89, v139
    v_fmac_f32 v14, v50, v38
    v_fmac_f32 v15, v50, v39
    v_lshlrev_b32 v32, 16, v140
    v_and_b32 v33, s89, v140
    v_fmac_f32 v16, v50, v32
    v_fmac_f32 v17, v50, v33
    v_lshlrev_b32 v34, 16, v141
    v_and_b32 v35, s89, v141
    v_fmac_f32 v18, v50, v34
    v_fmac_f32 v19, v50, v35
    v_lshlrev_b32 v36, 16, v142
    v_and_b32 v37, s89, v142
    v_fmac_f32 v20, v50, v36
    v_fmac_f32 v21, v50, v37
    v_lshlrev_b32 v38, 16, v143
    v_and_b32 v39, s89, v143
    v_fmac_f32 v22, v50, v38
    v_fmac_f32 v23, v50, v39
    v_lshlrev_b32 v32, 16, v144
    v_and_b32 v33, s89, v144
    v_fmac_f32 v24, v50, v32
    v_fmac_f32 v25, v50, v33
    v_lshlrev_b32 v34, 16, v145
    v_and_b32 v35, s89, v145
    v_fmac_f32 v26, v50, v34
    v_fmac_f32 v27, v50, v35
    v_lshlrev_b32 v36, 16, v146
    v_and_b32 v37, s89, v146
    v_fmac_f32 v28, v50, v36
    v_fmac_f32 v29, v50, v37
    v_lshlrev_b32 v38, 16, v147
    v_and_b32 v39, s89, v147
    v_fmac_f32 v30, v50, v38
    v_fmac_f32 v31, v50, v39
    s_waitcnt vmcnt(6)
    s_add_u32 s88, s87, 30720
    buffer_load_dwordx4 v[184:187], v2, s[36:39], s88 offen offset:0 nt
    buffer_load_dwordx4 v[188:191], v2, s[36:39], s88 offen offset:128 nt
    buffer_load_dwordx4 v[192:195], v2, s[36:39], s88 offen offset:256 nt
    v_lshlrev_b32 v32, 16, v148
    v_and_b32 v33, s89, v148
    v_fmac_f32 v8, v51, v32
    v_fmac_f32 v9, v51, v33
    v_lshlrev_b32 v34, 16, v149
    v_and_b32 v35, s89, v149
    v_fmac_f32 v10, v51, v34
    v_fmac_f32 v11, v51, v35
    v_lshlrev_b32 v36, 16, v150
    v_and_b32 v37, s89, v150
    v_fmac_f32 v12, v51, v36
    v_fmac_f32 v13, v51, v37
    v_lshlrev_b32 v38, 16, v151
    v_and_b32 v39, s89, v151
    v_fmac_f32 v14, v51, v38
    v_fmac_f32 v15, v51, v39
    v_lshlrev_b32 v32, 16, v152
    v_and_b32 v33, s89, v152
    v_fmac_f32 v16, v51, v32
    v_fmac_f32 v17, v51, v33
    v_lshlrev_b32 v34, 16, v153
    v_and_b32 v35, s89, v153
    v_fmac_f32 v18, v51, v34
    v_fmac_f32 v19, v51, v35
    v_lshlrev_b32 v36, 16, v154
    v_and_b32 v37, s89, v154
    v_fmac_f32 v20, v51, v36
    v_fmac_f32 v21, v51, v37
    v_lshlrev_b32 v38, 16, v155
    v_and_b32 v39, s89, v155
    v_fmac_f32 v22, v51, v38
    v_fmac_f32 v23, v51, v39
    v_lshlrev_b32 v32, 16, v156
    v_and_b32 v33, s89, v156
    v_fmac_f32 v24, v51, v32
    v_fmac_f32 v25, v51, v33
    v_lshlrev_b32 v34, 16, v157
    v_and_b32 v35, s89, v157
    v_fmac_f32 v26, v51, v34
    v_fmac_f32 v27, v51, v35
    v_lshlrev_b32 v36, 16, v158
    v_and_b32 v37, s89, v158
    v_fmac_f32 v28, v51, v36
    v_fmac_f32 v29, v51, v37
    v_lshlrev_b32 v38, 16, v159
    v_and_b32 v39, s89, v159
    v_fmac_f32 v30, v51, v38
    v_fmac_f32 v31, v51, v39
    s_waitcnt vmcnt(6)
    s_add_u32 s88, s87, 33792
    buffer_load_dwordx4 v[196:199], v2, s[36:39], s88 offen offset:0 nt
    buffer_load_dwordx4 v[200:203], v2, s[36:39], s88 offen offset:128 nt
    buffer_load_dwordx4 v[204:207], v2, s[36:39], s88 offen offset:256 nt
    v_lshlrev_b32 v32, 16, v160
    v_and_b32 v33, s89, v160
    v_fmac_f32 v8, v52, v32
    v_fmac_f32 v9, v52, v33
    v_lshlrev_b32 v34, 16, v161
    v_and_b32 v35, s89, v161
    v_fmac_f32 v10, v52, v34
    v_fmac_f32 v11, v52, v35
    v_lshlrev_b32 v36, 16, v162
    v_and_b32 v37, s89, v162
    v_fmac_f32 v12, v52, v36
    v_fmac_f32 v13, v52, v37
    v_lshlrev_b32 v38, 16, v163
    v_and_b32 v39, s89, v163
    v_fmac_f32 v14, v52, v38
    v_fmac_f32 v15, v52, v39
    v_lshlrev_b32 v32, 16, v164
    v_and_b32 v33, s89, v164
    v_fmac_f32 v16, v52, v32
    v_fmac_f32 v17, v52, v33
    v_lshlrev_b32 v34, 16, v165
    v_and_b32 v35, s89, v165
    v_fmac_f32 v18, v52, v34
    v_fmac_f32 v19, v52, v35
    v_lshlrev_b32 v36, 16, v166
    v_and_b32 v37, s89, v166
    v_fmac_f32 v20, v52, v36
    v_fmac_f32 v21, v52, v37
    v_lshlrev_b32 v38, 16, v167
    v_and_b32 v39, s89, v167
    v_fmac_f32 v22, v52, v38
    v_fmac_f32 v23, v52, v39
    v_lshlrev_b32 v32, 16, v168
    v_and_b32 v33, s89, v168
    v_fmac_f32 v24, v52, v32
    v_fmac_f32 v25, v52, v33
    v_lshlrev_b32 v34, 16, v169
    v_and_b32 v35, s89, v169
    v_fmac_f32 v26, v52, v34
    v_fmac_f32 v27, v52, v35
    v_lshlrev_b32 v36, 16, v170
    v_and_b32 v37, s89, v170
    v_fmac_f32 v28, v52, v36
    v_fmac_f32 v29, v52, v37
    v_lshlrev_b32 v38, 16, v171
    v_and_b32 v39, s89, v171
    v_fmac_f32 v30, v52, v38
    v_fmac_f32 v31, v52, v39
    s_waitcnt vmcnt(6)
    s_add_u32 s88, s87, 36864
    buffer_load_dwordx4 v[208:211], v2, s[36:39], s88 offen offset:0 nt
    buffer_load_dwordx4 v[212:215], v2, s[36:39], s88 offen offset:128 nt
    buffer_load_dwordx4 v[216:219], v2, s[36:39], s88 offen offset:256 nt
    v_lshlrev_b32 v32, 16, v172
    v_and_b32 v33, s89, v172
    v_fmac_f32 v8, v53, v32
    v_fmac_f32 v9, v53, v33
    v_lshlrev_b32 v34, 16, v173
    v_and_b32 v35, s89, v173
    v_fmac_f32 v10, v53, v34
    v_fmac_f32 v11, v53, v35
    v_lshlrev_b32 v36, 16, v174
    v_and_b32 v37, s89, v174
    v_fmac_f32 v12, v53, v36
    v_fmac_f32 v13, v53, v37
    v_lshlrev_b32 v38, 16, v175
    v_and_b32 v39, s89, v175
    v_fmac_f32 v14, v53, v38
    v_fmac_f32 v15, v53, v39
    v_lshlrev_b32 v32, 16, v176
    v_and_b32 v33, s89, v176
    v_fmac_f32 v16, v53, v32
    v_fmac_f32 v17, v53, v33
    v_lshlrev_b32 v34, 16, v177
    v_and_b32 v35, s89, v177
    v_fmac_f32 v18, v53, v34
    v_fmac_f32 v19, v53, v35
    v_lshlrev_b32 v36, 16, v178
    v_and_b32 v37, s89, v178
    v_fmac_f32 v20, v53, v36
    v_fmac_f32 v21, v53, v37
    v_lshlrev_b32 v38, 16, v179
    v_and_b32 v39, s89, v179
    v_fmac_f32 v22, v53, v38
    v_fmac_f32 v23, v53, v39
    v_lshlrev_b32 v32, 16, v180
    v_and_b32 v33, s89, v180
    v_fmac_f32 v24, v53, v32
    v_fmac_f32 v25, v53, v33
    v_lshlrev_b32 v34, 16, v181
    v_and_b32 v35, s89, v181
    v_fmac_f32 v26, v53, v34
    v_fmac_f32 v27, v53, v35
    v_lshlrev_b32 v36, 16, v182
    v_and_b32 v37, s89, v182
    v_fmac_f32 v28, v53, v36
    v_fmac_f32 v29, v53, v37
    v_lshlrev_b32 v38, 16, v183
    v_and_b32 v39, s89, v183
    v_fmac_f32 v30, v53, v38
    v_fmac_f32 v31, v53, v39
    s_waitcnt vmcnt(6)
    s_add_u32 s88, s87, 39936
    buffer_load_dwordx4 v[220:223], v2, s[36:39], s88 offen offset:0 nt
    buffer_load_dwordx4 v[224:227], v2, s[36:39], s88 offen offset:128 nt
    buffer_load_dwordx4 v[228:231], v2, s[36:39], s88 offen offset:256 nt
    v_lshlrev_b32 v32, 16, v184
    v_and_b32 v33, s89, v184
    v_fmac_f32 v8, v54, v32
    v_fmac_f32 v9, v54, v33
    v_lshlrev_b32 v34, 16, v185
    v_and_b32 v35, s89, v185
    v_fmac_f32 v10, v54, v34
    v_fmac_f32 v11, v54, v35
    v_lshlrev_b32 v36, 16, v186
    v_and_b32 v37, s89, v186
    v_fmac_f32 v12, v54, v36
    v_fmac_f32 v13, v54, v37
    v_lshlrev_b32 v38, 16, v187
    v_and_b32 v39, s89, v187
    v_fmac_f32 v14, v54, v38
    v_fmac_f32 v15, v54, v39
    v_lshlrev_b32 v32, 16, v188
    v_and_b32 v33, s89, v188
    v_fmac_f32 v16, v54, v32
    v_fmac_f32 v17, v54, v33
    v_lshlrev_b32 v34, 16, v189
    v_and_b32 v35, s89, v189
    v_fmac_f32 v18, v54, v34
    v_fmac_f32 v19, v54, v35
    v_lshlrev_b32 v36, 16, v190
    v_and_b32 v37, s89, v190
    v_fmac_f32 v20, v54, v36
    v_fmac_f32 v21, v54, v37
    v_lshlrev_b32 v38, 16, v191
    v_and_b32 v39, s89, v191
    v_fmac_f32 v22, v54, v38
    v_fmac_f32 v23, v54, v39
    v_lshlrev_b32 v32, 16, v192
    v_and_b32 v33, s89, v192
    v_fmac_f32 v24, v54, v32
    v_fmac_f32 v25, v54, v33
    v_lshlrev_b32 v34, 16, v193
    v_and_b32 v35, s89, v193
    v_fmac_f32 v26, v54, v34
    v_fmac_f32 v27, v54, v35
    v_lshlrev_b32 v36, 16, v194
    v_and_b32 v37, s89, v194
    v_fmac_f32 v28, v54, v36
    v_fmac_f32 v29, v54, v37
    v_lshlrev_b32 v38, 16, v195
    v_and_b32 v39, s89, v195
    v_fmac_f32 v30, v54, v38
    v_fmac_f32 v31, v54, v39
    s_waitcnt vmcnt(6)
    s_add_u32 s88, s87, 43008
    buffer_load_dwordx4 v[232:235], v2, s[36:39], s88 offen offset:0 nt
    buffer_load_dwordx4 v[236:239], v2, s[36:39], s88 offen offset:128 nt
    buffer_load_dwordx4 v[240:243], v2, s[36:39], s88 offen offset:256 nt
    v_lshlrev_b32 v32, 16, v196
    v_and_b32 v33, s89, v196
    v_fmac_f32 v8, v55, v32
    v_fmac_f32 v9, v55, v33
    v_lshlrev_b32 v34, 16, v197
    v_and_b32 v35, s89, v197
    v_fmac_f32 v10, v55, v34
    v_fmac_f32 v11, v55, v35
    v_lshlrev_b32 v36, 16, v198
    v_and_b32 v37, s89, v198
    v_fmac_f32 v12, v55, v36
    v_fmac_f32 v13, v55, v37
    v_lshlrev_b32 v38, 16, v199
    v_and_b32 v39, s89, v199
    v_fmac_f32 v14, v55, v38
    v_fmac_f32 v15, v55, v39
    v_lshlrev_b32 v32, 16, v200
    v_and_b32 v33, s89, v200
    v_fmac_f32 v16, v55, v32
    v_fmac_f32 v17, v55, v33
    v_lshlrev_b32 v34, 16, v201
    v_and_b32 v35, s89, v201
    v_fmac_f32 v18, v55, v34
    v_fmac_f32 v19, v55, v35
    v_lshlrev_b32 v36, 16, v202
    v_and_b32 v37, s89, v202
    v_fmac_f32 v20, v55, v36
    v_fmac_f32 v21, v55, v37
    v_lshlrev_b32 v38, 16, v203
    v_and_b32 v39, s89, v203
    v_fmac_f32 v22, v55, v38
    v_fmac_f32 v23, v55, v39
    v_lshlrev_b32 v32, 16, v204
    v_and_b32 v33, s89, v204
    v_fmac_f32 v24, v55, v32
    v_fmac_f32 v25, v55, v33
    v_lshlrev_b32 v34, 16, v205
    v_and_b32 v35, s89, v205
    v_fmac_f32 v26, v55, v34
    v_fmac_f32 v27, v55, v35
    v_lshlrev_b32 v36, 16, v206
    v_and_b32 v37, s89, v206
    v_fmac_f32 v28, v55, v36
    v_fmac_f32 v29, v55, v37
    v_lshlrev_b32 v38, 16, v207
    v_and_b32 v39, s89, v207
    v_fmac_f32 v30, v55, v38
    v_fmac_f32 v31, v55, v39
    s_waitcnt vmcnt(6)
    s_add_u32 s88, s87, 46080
    buffer_load_dwordx4 v[244:247], v2, s[36:39], s88 offen offset:0 nt
    buffer_load_dwordx4 v[248:251], v2, s[36:39], s88 offen offset:128 nt
    buffer_load_dwordx4 v[252:255], v2, s[36:39], s88 offen offset:256 nt
    v_lshlrev_b32 v32, 16, v208
    v_and_b32 v33, s89, v208
    v_fmac_f32 v8, v56, v32
    v_fmac_f32 v9, v56, v33
    v_lshlrev_b32 v34, 16, v209
    v_and_b32 v35, s89, v209
    v_fmac_f32 v10, v56, v34
    v_fmac_f32 v11, v56, v35
    v_lshlrev_b32 v36, 16, v210
    v_and_b32 v37, s89, v210
    v_fmac_f32 v12, v56, v36
    v_fmac_f32 v13, v56, v37
    v_lshlrev_b32 v38, 16, v211
    v_and_b32 v39, s89, v211
    v_fmac_f32 v14, v56, v38
    v_fmac_f32 v15, v56, v39
    v_lshlrev_b32 v32, 16, v212
    v_and_b32 v33, s89, v212
    v_fmac_f32 v16, v56, v32
    v_fmac_f32 v17, v56, v33
    v_lshlrev_b32 v34, 16, v213
    v_and_b32 v35, s89, v213
    v_fmac_f32 v18, v56, v34
    v_fmac_f32 v19, v56, v35
    v_lshlrev_b32 v36, 16, v214
    v_and_b32 v37, s89, v214
    v_fmac_f32 v20, v56, v36
    v_fmac_f32 v21, v56, v37
    v_lshlrev_b32 v38, 16, v215
    v_and_b32 v39, s89, v215
    v_fmac_f32 v22, v56, v38
    v_fmac_f32 v23, v56, v39
    v_lshlrev_b32 v32, 16, v216
    v_and_b32 v33, s89, v216
    v_fmac_f32 v24, v56, v32
    v_fmac_f32 v25, v56, v33
    v_lshlrev_b32 v34, 16, v217
    v_and_b32 v35, s89, v217
    v_fmac_f32 v26, v56, v34
    v_fmac_f32 v27, v56, v35
    v_lshlrev_b32 v36, 16, v218
    v_and_b32 v37, s89, v218
    v_fmac_f32 v28, v56, v36
    v_fmac_f32 v29, v56, v37
    v_lshlrev_b32 v38, 16, v219
    v_and_b32 v39, s89, v219
    v_fmac_f32 v30, v56, v38
    v_fmac_f32 v31, v56, v39
    s_waitcnt vmcnt(6)
    v_lshlrev_b32 v32, 16, v220
    v_and_b32 v33, s89, v220
    v_fmac_f32 v8, v57, v32
    v_fmac_f32 v9, v57, v33
    v_lshlrev_b32 v34, 16, v221
    v_and_b32 v35, s89, v221
    v_fmac_f32 v10, v57, v34
    v_fmac_f32 v11, v57, v35
    v_lshlrev_b32 v36, 16, v222
    v_and_b32 v37, s89, v222
    v_fmac_f32 v12, v57, v36
    v_fmac_f32 v13, v57, v37
    v_lshlrev_b32 v38, 16, v223
    v_and_b32 v39, s89, v223
    v_fmac_f32 v14, v57, v38
    v_fmac_f32 v15, v57, v39
    v_lshlrev_b32 v32, 16, v224
    v_and_b32 v33, s89, v224
    v_fmac_f32 v16, v57, v32
    v_fmac_f32 v17, v57, v33
    v_lshlrev_b32 v34, 16, v225
    v_and_b32 v35, s89, v225
    v_fmac_f32 v18, v57, v34
    v_fmac_f32 v19, v57, v35
    v_lshlrev_b32 v36, 16, v226
    v_and_b32 v37, s89, v226
    v_fmac_f32 v20, v57, v36
    v_fmac_f32 v21, v57, v37
    v_lshlrev_b32 v38, 16, v227
    v_and_b32 v39, s89, v227
    v_fmac_f32 v22, v57, v38
    v_fmac_f32 v23, v57, v39
    v_lshlrev_b32 v32, 16, v228
    v_and_b32 v33, s89, v228
    v_fmac_f32 v24, v57, v32
    v_fmac_f32 v25, v57, v33
    v_lshlrev_b32 v34, 16, v229
    v_and_b32 v35, s89, v229
    v_fmac_f32 v26, v57, v34
    v_fmac_f32 v27, v57, v35
    v_lshlrev_b32 v36, 16, v230
    v_and_b32 v37, s89, v230
    v_fmac_f32 v28, v57, v36
    v_fmac_f32 v29, v57, v37
    v_lshlrev_b32 v38, 16, v231
    v_and_b32 v39, s89, v231
    v_fmac_f32 v30, v57, v38
    v_fmac_f32 v31, v57, v39
    s_waitcnt vmcnt(3)
    v_lshlrev_b32 v32, 16, v232
    v_and_b32 v33, s89, v232
    v_fmac_f32 v8, v58, v32
    v_fmac_f32 v9, v58, v33
    v_lshlrev_b32 v34, 16, v233
    v_and_b32 v35, s89, v233
    v_fmac_f32 v10, v58, v34
    v_fmac_f32 v11, v58, v35
    v_lshlrev_b32 v36, 16, v234
    v_and_b32 v37, s89, v234
    v_fmac_f32 v12, v58, v36
    v_fmac_f32 v13, v58, v37
    v_lshlrev_b32 v38, 16, v235
    v_and_b32 v39, s89, v235
    v_fmac_f32 v14, v58, v38
    v_fmac_f32 v15, v58, v39
    v_lshlrev_b32 v32, 16, v236
    v_and_b32 v33, s89, v236
    v_fmac_f32 v16, v58, v32
    v_fmac_f32 v17, v58, v33
    v_lshlrev_b32 v34, 16, v237
    v_and_b32 v35, s89, v237
    v_fmac_f32 v18, v58, v34
    v_fmac_f32 v19, v58, v35
    v_lshlrev_b32 v36, 16, v238
    v_and_b32 v37, s89, v238
    v_fmac_f32 v20, v58, v36
    v_fmac_f32 v21, v58, v37
    v_lshlrev_b32 v38, 16, v239
    v_and_b32 v39, s89, v239
    v_fmac_f32 v22, v58, v38
    v_fmac_f32 v23, v58, v39
    v_lshlrev_b32 v32, 16, v240
    v_and_b32 v33, s89, v240
    v_fmac_f32 v24, v58, v32
    v_fmac_f32 v25, v58, v33
    v_lshlrev_b32 v34, 16, v241
    v_and_b32 v35, s89, v241
    v_fmac_f32 v26, v58, v34
    v_fmac_f32 v27, v58, v35
    v_lshlrev_b32 v36, 16, v242
    v_and_b32 v37, s89, v242
    v_fmac_f32 v28, v58, v36
    v_fmac_f32 v29, v58, v37
    v_lshlrev_b32 v38, 16, v243
    v_and_b32 v39, s89, v243
    v_fmac_f32 v30, v58, v38
    v_fmac_f32 v31, v58, v39
    s_waitcnt vmcnt(0)
    v_lshlrev_b32 v32, 16, v244
    v_and_b32 v33, s89, v244
    v_fmac_f32 v8, v59, v32
    v_fmac_f32 v9, v59, v33
    v_lshlrev_b32 v34, 16, v245
    v_and_b32 v35, s89, v245
    v_fmac_f32 v10, v59, v34
    v_fmac_f32 v11, v59, v35
    v_lshlrev_b32 v36, 16, v246
    v_and_b32 v37, s89, v246
    v_fmac_f32 v12, v59, v36
    v_fmac_f32 v13, v59, v37
    v_lshlrev_b32 v38, 16, v247
    v_and_b32 v39, s89, v247
    v_fmac_f32 v14, v59, v38
    v_fmac_f32 v15, v59, v39
    v_lshlrev_b32 v32, 16, v248
    v_and_b32 v33, s89, v248
    v_fmac_f32 v16, v59, v32
    v_fmac_f32 v17, v59, v33
    v_lshlrev_b32 v34, 16, v249
    v_and_b32 v35, s89, v249
    v_fmac_f32 v18, v59, v34
    v_fmac_f32 v19, v59, v35
    v_lshlrev_b32 v36, 16, v250
    v_and_b32 v37, s89, v250
    v_fmac_f32 v20, v59, v36
    v_fmac_f32 v21, v59, v37
    v_lshlrev_b32 v38, 16, v251
    v_and_b32 v39, s89, v251
    v_fmac_f32 v22, v59, v38
    v_fmac_f32 v23, v59, v39
    v_lshlrev_b32 v32, 16, v252
    v_and_b32 v33, s89, v252
    v_fmac_f32 v24, v59, v32
    v_fmac_f32 v25, v59, v33
    v_lshlrev_b32 v34, 16, v253
    v_and_b32 v35, s89, v253
    v_fmac_f32 v26, v59, v34
    v_fmac_f32 v27, v59, v35
    v_lshlrev_b32 v36, 16, v254
    v_and_b32 v37, s89, v254
    v_fmac_f32 v28, v59, v36
    v_fmac_f32 v29, v59, v37
    v_lshlrev_b32 v38, 16, v255
    v_and_b32 v39, s89, v255
    v_fmac_f32 v30, v59, v38
    v_fmac_f32 v31, v59, v39
    v_lshlrev_b32 v44, 16, v88
    v_and_b32 v45, s89, v88
    v_lshlrev_b32 v46, 16, v96
    v_and_b32 v47, s89, v96
    v_mul_f32 v44, v44, v46
    v_mul_f32 v45, v45, v47
    v_cvt_pk_bf16_f32 v46, v44, v45
    v_lshlrev_b32 v44, 16, v46
    v_and_b32 v45, s89, v46
    v_add_f32 v48, v44, v45
    v_lshlrev_b32 v44, 16, v89
    v_and_b32 v45, s89, v89
    v_lshlrev_b32 v46, 16, v97
    v_and_b32 v47, s89, v97
    v_mul_f32 v44, v44, v46
    v_mul_f32 v45, v45, v47
    v_cvt_pk_bf16_f32 v46, v44, v45
    v_lshlrev_b32 v44, 16, v46
    v_and_b32 v45, s89, v46
    v_add_f32 v48, v48, v44
    v_add_f32 v48, v48, v45
    v_lshlrev_b32 v44, 16, v90
    v_and_b32 v45, s89, v90
    v_lshlrev_b32 v46, 16, v98
    v_and_b32 v47, s89, v98
    v_mul_f32 v44, v44, v46
    v_mul_f32 v45, v45, v47
    v_cvt_pk_bf16_f32 v46, v44, v45
    v_lshlrev_b32 v44, 16, v46
    v_and_b32 v45, s89, v46
    v_add_f32 v48, v48, v44
    v_add_f32 v48, v48, v45
    v_lshlrev_b32 v44, 16, v91
    v_and_b32 v45, s89, v91
    v_lshlrev_b32 v46, 16, v99
    v_and_b32 v47, s89, v99
    v_mul_f32 v44, v44, v46
    v_mul_f32 v45, v45, v47
    v_cvt_pk_bf16_f32 v46, v44, v45
    v_lshlrev_b32 v44, 16, v46
    v_and_b32 v45, s89, v46
    v_add_f32 v48, v48, v44
    v_add_f32 v48, v48, v45
    v_lshlrev_b32 v44, 16, v92
    v_and_b32 v45, s89, v92
    v_lshlrev_b32 v46, 16, v100
    v_and_b32 v47, s89, v100
    v_mul_f32 v44, v44, v46
    v_mul_f32 v45, v45, v47
    v_cvt_pk_bf16_f32 v46, v44, v45
    v_lshlrev_b32 v44, 16, v46
    v_and_b32 v45, s89, v46
    v_add_f32 v48, v48, v44
    v_add_f32 v48, v48, v45
    v_permlane32_swap_b32 v8, v9
    v_permlane32_swap_b32 v10, v11
    v_permlane32_swap_b32 v12, v13
    v_permlane32_swap_b32 v14, v15
    v_permlane32_swap_b32 v16, v17
    v_permlane32_swap_b32 v18, v19
    v_permlane32_swap_b32 v20, v21
    v_permlane32_swap_b32 v22, v23
    v_permlane32_swap_b32 v24, v25
    v_permlane32_swap_b32 v26, v27
    v_permlane32_swap_b32 v28, v29
    v_permlane32_swap_b32 v30, v31
    v_add_f32 v8, v8, v9
    v_add_f32 v10, v10, v11
    v_add_f32 v12, v12, v13
    v_add_f32 v14, v14, v15
    v_add_f32 v16, v16, v17
    v_add_f32 v18, v18, v19
    v_add_f32 v20, v20, v21
    v_add_f32 v22, v22, v23
    v_add_f32 v24, v24, v25
    v_add_f32 v26, v26, v27
    v_add_f32 v28, v28, v29
    v_add_f32 v30, v30, v31
    v_permlane16_swap_b32 v8, v10
    v_permlane16_swap_b32 v12, v14
    v_permlane16_swap_b32 v16, v18
    v_permlane16_swap_b32 v20, v22
    v_permlane16_swap_b32 v24, v26
    v_permlane16_swap_b32 v28, v30
    v_add_f32 v8, v8, v10
    v_add_f32 v12, v12, v14
    v_add_f32 v16, v16, v18
    v_add_f32 v20, v20, v22
    v_add_f32 v24, v24, v26
    v_add_f32 v28, v28, v30
    v_add_f32_dpp v8, v8, v8 row_ror:8 row_mask:0xf bank_mask:0xf
    v_add_f32_dpp v12, v12, v12 row_ror:8 row_mask:0xf bank_mask:0xf
    v_add_f32_dpp v16, v16, v16 row_ror:8 row_mask:0xf bank_mask:0xf
    v_add_f32_dpp v20, v20, v20 row_ror:8 row_mask:0xf bank_mask:0xf
    v_add_f32_dpp v24, v24, v24 row_ror:8 row_mask:0xf bank_mask:0xf
    v_add_f32_dpp v28, v28, v28 row_ror:8 row_mask:0xf bank_mask:0xf
    ds_write_b32 v7, v8 offset:0
    ds_write_b32 v7, v12 offset:16
    ds_write_b32 v7, v16 offset:256
    ds_write_b32 v7, v20 offset:272
    ds_write_b32 v7, v24 offset:512
    ds_write_b32 v7, v28 offset:528
    v_add_f32_dpp v5, v5, v5 row_shr:1 row_mask:0xf bank_mask:0xf bound_ctrl:0
    v_add_f32_dpp v48, v48, v48 row_shr:1 row_mask:0xf bank_mask:0xf bound_ctrl:0
    s_nop 0
    v_add_f32_dpp v5, v5, v5 row_shr:2 row_mask:0xf bank_mask:0xf bound_ctrl:0
    v_add_f32_dpp v48, v48, v48 row_shr:2 row_mask:0xf bank_mask:0xf bound_ctrl:0
    s_nop 0
    v_add_f32_dpp v5, v5, v5 row_shr:4 row_mask:0xf bank_mask:0xf bound_ctrl:0
    v_add_f32_dpp v48, v48, v48 row_shr:4 row_mask:0xf bank_mask:0xf bound_ctrl:0
    s_nop 0
    v_add_f32_dpp v5, v5, v5 row_shr:8 row_mask:0xf bank_mask:0xf bound_ctrl:0
    v_add_f32_dpp v48, v48, v48 row_shr:8 row_mask:0xf bank_mask:0xf bound_ctrl:0
    s_nop 0
    v_add_f32_dpp v5, v5, v5 row_bcast:15 row_mask:0xa bank_mask:0xf
    v_add_f32_dpp v48, v48, v48 row_bcast:15 row_mask:0xa bank_mask:0xf
    s_nop 0
    v_add_f32_dpp v5, v5, v5 row_bcast:31 row_mask:0xc bank_mask:0xf
    v_add_f32_dpp v48, v48, v48 row_bcast:31 row_mask:0xc bank_mask:0xf
    s_mov_b32 s90, 0x3e000000
    v_mul_f32 v5, s90, v5
    s_lshl_b32 s90, s82, 3
    s_add_u32 s90, s90, 9600
    v_mov_b32 v63, s90
    v_mov_b32 v4, v6
    s_mov_b32 exec_lo, 0
    s_mov_b32 exec_hi, 0x80000000
    ds_write_b64 v63, v[4:5]
    s_mov_b64 exec, -1
    v_cvt_pk_bf16_f32 v44, v48, v48
    v_lshlrev_b32 v48, 16, v44
    s_mov_b32 s90, 0x3fb8aa3b
    v_mul_f32 v48, s90, v48
    v_exp_f32 v48, -v48
    s_nop 0
    v_add_f32 v48, 1.0, v48
    v_rcp_f32 v48, v48
    s_nop 0
    v_cvt_pk_bf16_f32 v44, v48, v48
    v_lshlrev_b32 v48, 16, v44
    s_nop 0
    v_readlane_b32 s91, v48, 63
    v_lshlrev_b32 v7, 2, v0
    s_waitcnt lgkmcnt(0)
    s_barrier
    s_lshl_b32 s86, s80, 13
    s_cmp_ge_u32 s82, 3
    s_cbranch_scc1 L_pub
    v_mov_b32 v4, 9600
    ds_read_b128 v[104:107], v4 offset:0
    ds_read_b128 v[108:111], v4 offset:16
    ds_read_b128 v[112:115], v4 offset:32
    ds_read_b128 v[116:119], v4 offset:48
    ds_read_b32 v120, v7 offset:0
    ds_read_b32 v121, v7 offset:768
    ds_read_b32 v122, v7 offset:1536
    ds_read_b32 v123, v7 offset:2304
    ds_read_b32 v124, v7 offset:3072
    ds_read_b32 v125, v7 offset:3840
    ds_read_b32 v126, v7 offset:4608
    ds_read_b32 v127, v7 offset:5376
    s_waitcnt lgkmcnt(0)
    v_max3_f32 v128, v104, v106, v108
    v_max3_f32 v129, v110, v112, v114
    v_max3_f32 v128, v128, v116, v118
    v_max_f32 v128, v128, v129
    v_sub_f32 v132, v104, v128
    v_sub_f32 v133, v106, v128
    v_sub_f32 v134, v108, v128
    v_sub_f32 v135, v110, v128
    v_sub_f32 v136, v112, v128
    v_sub_f32 v137, v114, v128
    v_sub_f32 v138, v116, v128
    v_sub_f32 v139, v118, v128
    v_mul_f32 v132, s90, v132
    v_mul_f32 v133, s90, v133
    v_mul_f32 v134, s90, v134
    v_mul_f32 v135, s90, v135
    v_mul_f32 v136, s90, v136
    v_mul_f32 v137, s90, v137
    v_mul_f32 v138, s90, v138
    v_mul_f32 v139, s90, v139
    v_exp_f32 v132, v132
    v_exp_f32 v133, v133
    v_exp_f32 v134, v134
    v_exp_f32 v135, v135
    v_exp_f32 v136, v136
    v_exp_f32 v137, v137
    v_exp_f32 v138, v138
    v_exp_f32 v139, v139
    v_mul_f32 v130, v132, v120
    v_mul_f32 v129, v132, v105
    v_fmac_f32 v130, v133, v121
    v_fmac_f32 v129, v133, v107
    v_fmac_f32 v130, v134, v122
    v_fmac_f32 v129, v134, v109
    v_fmac_f32 v130, v135, v123
    v_fmac_f32 v129, v135, v111
    v_fmac_f32 v130, v136, v124
    v_fmac_f32 v129, v136, v113
    v_fmac_f32 v130, v137, v125
    v_fmac_f32 v129, v137, v115
    v_fmac_f32 v130, v138, v126
    v_fmac_f32 v129, v138, v117
    v_fmac_f32 v130, v139, v127
    v_fmac_f32 v129, v139, v119
    s_lshl_b32 s83, s81, 10
    s_add_u32 s83, s83, s86
    buffer_store_dword v130, v7, s[56:59], s83 offen sc0 sc1
    s_cmp_lg_u32 s82, 0
    s_cbranch_scc1 L_pub
    s_mov_b64 exec, 1
    buffer_store_dwordx2 v[128:129], v7, s[56:59], s83 offen offset:768 sc0 sc1
    s_mov_b64 exec, -1
L_pub:
    s_nop 3
    s_waitcnt vmcnt(0)
    s_barrier
    s_cmp_lg_u32 s82, 0
    s_cbranch_scc1 L_polled
    v_mov_b32 v104, 1
    v_mov_b32 v105, 0
    s_mov_b64 exec, 1
    buffer_store_dword v104, v105, s[56:59], s3 offen sc0 sc1
    s_mov_b64 exec, -1
    s_mov_b32 s83, 0
L_poll1:
    s_nop 3
    v_readfirstlane_b32 s90, v102
    s_nop 1
    s_cmp_ge_u32 s90, 8
    s_cbranch_scc1 L_poll2
    s_add_u32 s83, s83, 1
    s_cmp_ge_u32 s83, 0x400000
    s_cbranch_scc1 L_poll2
    s_sleep 2
    buffer_load_dword v102, v101, s[76:79], 0 offen sc0 sc1
    s_waitcnt vmcnt(0)
    s_branch L_poll1
L_poll2:
    s_nop 3
    s_andn2_b32 s90, s3, 0xff
    v_and_b32 v105, 7, v1
    v_lshlrev_b32 v105, 2, v105
L_poll3:
    s_nop 3
    buffer_load_dword v104, v105, s[56:59], s90 offen sc0 sc1
    s_waitcnt vmcnt(0)
    v_cmp_ne_u32 vcc, 1, v104
    s_nop 1
    s_cmp_eq_u64 vcc, 0
    s_cbranch_scc1 L_polled
    s_add_u32 s83, s83, 1
    s_cmp_ge_u32 s83, 0x400000
    s_cbranch_scc1 L_polled
    s_sleep 1
    s_branch L_poll3
L_polled:
    s_nop 3
    s_barrier
    s_cmp_ge_u32 s82, 3
    s_cbranch_scc1 L_rec_h
    v_mov_b32 v8, 768
    s_add_u32 s87, s86, 0
    buffer_load_dwordx2 v[104:105], v8, s[56:59], s87 offen sc0 sc1
    buffer_load_dword v120, v7, s[56:59], s87 offen sc0 sc1
    s_add_u32 s87, s86, 1024
    buffer_load_dwordx2 v[106:107], v8, s[56:59], s87 offen sc0 sc1
    buffer_load_dword v121, v7, s[56:59], s87 offen sc0 sc1
    s_add_u32 s87, s86, 2048
    buffer_load_dwordx2 v[108:109], v8, s[56:59], s87 offen sc0 sc1
    buffer_load_dword v122, v7, s[56:59], s87 offen sc0 sc1
    s_add_u32 s87, s86, 3072
    buffer_load_dwordx2 v[110:111], v8, s[56:59], s87 offen sc0 sc1
    buffer_load_dword v123, v7, s[56:59], s87 offen sc0 sc1
    s_add_u32 s87, s86, 4096
    buffer_load_dwordx2 v[112:113], v8, s[56:59], s87 offen sc0 sc1
    buffer_load_dword v124, v7, s[56:59], s87 offen sc0 sc1
    s_add_u32 s87, s86, 5120
    buffer_load_dwordx2 v[114:115], v8, s[56:59], s87 offen sc0 sc1
    buffer_load_dword v125, v7, s[56:59], s87 offen sc0 sc1
    s_add_u32 s87, s86, 6144
    buffer_load_dwordx2 v[116:117], v8, s[56:59], s87 offen sc0 sc1
    buffer_load_dword v126, v7, s[56:59], s87 offen sc0 sc1
    s_add_u32 s87, s86, 7168
    buffer_load_dwordx2 v[118:119], v8, s[56:59], s87 offen sc0 sc1
    buffer_load_dword v127, v7, s[56:59], s87 offen sc0 sc1
    s_waitcnt vmcnt(0)
    v_max3_f32 v30, v104, v106, v108
    v_max3_f32 v31, v110, v112, v114
    v_max3_f32 v30, v30, v116, v118
    v_max_f32 v30, v30, v31
    s_mov_b32 s90, 0x3fb8aa3b
    v_sub_f32 v32, v104, v30
    v_sub_f32 v33, v106, v30
    v_sub_f32 v34, v108, v30
    v_sub_f32 v35, v110, v30
    v_sub_f32 v36, v112, v30
    v_sub_f32 v37, v114, v30
    v_sub_f32 v38, v116, v30
    v_sub_f32 v39, v118, v30
    v_mul_f32 v32, s90, v32
    v_mul_f32 v33, s90, v33
    v_mul_f32 v34, s90, v34
    v_mul_f32 v35, s90, v35
    v_mul_f32 v36, s90, v36
    v_mul_f32 v37, s90, v37
    v_mul_f32 v38, s90, v38
    v_mul_f32 v39, s90, v39
    v_exp_f32 v32, v32
    v_exp_f32 v33, v33
    v_exp_f32 v34, v34
    v_exp_f32 v35, v35
    v_exp_f32 v36, v36
    v_exp_f32 v37, v37
    v_exp_f32 v38, v38
    v_exp_f32 v39, v39
    v_mul_f32 v40, v32, v120
    v_mul_f32 v41, v32, v105
    v_fmac_f32 v40, v33, v121
    v_fmac_f32 v41, v33, v107
    v_fmac_f32 v40, v34, v122
    v_fmac_f32 v41, v34, v109
    v_fmac_f32 v40, v35, v123
    v_fmac_f32 v41, v35, v111
    v_fmac_f32 v40, v36, v124
    v_fmac_f32 v41, v36, v113
    v_fmac_f32 v40, v37, v125
    v_fmac_f32 v41, v37, v115
    v_fmac_f32 v40, v38, v126
    v_fmac_f32 v41, v38, v117
    v_fmac_f32 v40, v39, v127
    v_fmac_f32 v41, v39, v119
    v_rcp_f32 v42, v41
    s_nop 0
    v_mul_f32 v43, v40, v42
    v_fma_f32 v44, -v43, v41, v40
    v_fmac_f32 v43, v44, v42
    v_cvt_pk_bf16_f32 v44, v43, v43
    v_lshlrev_b32 v43, 16, v44
    ds_write_b32 v7, v43 offset:10240
    s_branch L_rec_join
L_rec_h:
    s_nop 3
    s_cmp_lg_u32 s82, 3
    s_cbranch_scc1 L_rec_join
    v_lshlrev_b32 v4, 2, v1
    s_lshl_b32 s87, s80, 12
    s_add_u32 s87, s87, 524288
    buffer_load_dword v104, v4, s[56:59], s87 offen offset:0 sc0 sc1
    buffer_load_dword v112, v4, s[56:59], s87 offen offset:192 sc0 sc1
    buffer_load_dword v105, v4, s[56:59], s87 offen offset:512 sc0 sc1
    buffer_load_dword v113, v4, s[56:59], s87 offen offset:704 sc0 sc1
    buffer_load_dword v106, v4, s[56:59], s87 offen offset:1024 sc0 sc1
    buffer_load_dword v114, v4, s[56:59], s87 offen offset:1216 sc0 sc1
    buffer_load_dword v107, v4, s[56:59], s87 offen offset:1536 sc0 sc1
    buffer_load_dword v115, v4, s[56:59], s87 offen offset:1728 sc0 sc1
    buffer_load_dword v108, v4, s[56:59], s87 offen offset:2048 sc0 sc1
    buffer_load_dword v116, v4, s[56:59], s87 offen offset:2240 sc0 sc1
    buffer_load_dword v109, v4, s[56:59], s87 offen offset:2560 sc0 sc1
    buffer_load_dword v117, v4, s[56:59], s87 offen offset:2752 sc0 sc1
    buffer_load_dword v110, v4, s[56:59], s87 offen offset:3072 sc0 sc1
    buffer_load_dword v118, v4, s[56:59], s87 offen offset:3264 sc0 sc1
    buffer_load_dword v111, v4, s[56:59], s87 offen offset:3584 sc0 sc1
    buffer_load_dword v119, v4, s[56:59], s87 offen offset:3776 sc0 sc1
    s_waitcnt vmcnt(0)
    v_add_f32 v104, v104, v105
    v_add_f32 v106, v106, v107
    v_add_f32 v108, v108, v109
    v_add_f32 v110, v110, v111
    v_add_f32 v104, v104, v106
    v_add_f32 v108, v108, v110
    v_add_f32 v104, v104, v108
    v_add_f32 v112, v112, v113
    v_add_f32 v114, v114, v115
    v_add_f32 v116, v116, v117
    v_add_f32 v118, v118, v119
    v_add_f32 v112, v112, v114
    v_add_f32 v116, v116, v118
    v_add_f32 v112, v112, v116
    v_cvt_pk_bf16_f32 v105, v104, v112
    v_lshlrev_b32 v104, 16, v105
    v_and_b32 v112, s89, v105
    v_mul_f32 v104, v104, v112
    v_cvt_pk_bf16_f32 v105, v104, v104
    v_lshlrev_b32 v104, 16, v105
    s_mov_b32 exec_hi, 0xffff
    ds_write_b32 v4, v104 offset:11008
    s_mov_b64 exec, -1
L_rec_join:
    s_nop 3
    s_waitcnt lgkmcnt(0)
    s_barrier
    s_mul_i32 s90, s82, 96
    v_lshlrev_b32 v8, 2, v60
    v_add_u32 v9, s90, v8
    ds_read_b32 v50, v9 offset:10240
    ds_read_b32 v51, v9 offset:10264
    ds_read_b32 v52, v9 offset:10288
    ds_read_b32 v53, v9 offset:10312
    s_mul_i32 s90, s82, 24
    v_add_u32 v9, s90, v8
    ds_read_b32 v54, v9 offset:11008
    s_waitcnt lgkmcnt(0)
    v_lshlrev_b32 v44, 16, v64
    v_and_b32 v45, s89, v64
    v_mul_f32 v120, v50, v44
    v_mul_f32 v121, v50, v45
    v_lshlrev_b32 v44, 16, v65
    v_and_b32 v45, s89, v65
    v_mul_f32 v122, v50, v44
    v_mul_f32 v123, v50, v45
    v_lshlrev_b32 v44, 16, v66
    v_and_b32 v45, s89, v66
    v_mul_f32 v124, v50, v44
    v_mul_f32 v125, v50, v45
    v_lshlrev_b32 v44, 16, v67
    v_and_b32 v45, s89, v67
    v_mul_f32 v126, v50, v44
    v_mul_f32 v127, v50, v45
    v_lshlrev_b32 v44, 16, v68
    v_and_b32 v45, s89, v68
    v_fmac_f32 v120, v51, v44
    v_fmac_f32 v121, v51, v45
    v_lshlrev_b32 v44, 16, v69
    v_and_b32 v45, s89, v69
    v_fmac_f32 v122, v51, v44
    v_fmac_f32 v123, v51, v45
    v_lshlrev_b32 v44, 16, v70
    v_and_b32 v45, s89, v70
    v_fmac_f32 v124, v51, v44
    v_fmac_f32 v125, v51, v45
    v_lshlrev_b32 v44, 16, v71
    v_and_b32 v45, s89, v71
    v_fmac_f32 v126, v51, v44
    v_fmac_f32 v127, v51, v45
    v_lshlrev_b32 v44, 16, v72
    v_and_b32 v45, s89, v72
    v_fmac_f32 v120, v52, v44
    v_fmac_f32 v121, v52, v45
    v_lshlrev_b32 v44, 16, v73
    v_and_b32 v45, s89, v73
    v_fmac_f32 v122, v52, v44
    v_fmac_f32 v123, v52, v45
    v_lshlrev_b32 v44, 16, v74
    v_and_b32 v45, s89, v74
    v_fmac_f32 v124, v52, v44
    v_fmac_f32 v125, v52, v45
    v_lshlrev_b32 v44, 16, v75
    v_and_b32 v45, s89, v75
    v_fmac_f32 v126, v52, v44
    v_fmac_f32 v127, v52, v45
    v_lshlrev_b32 v44, 16, v76
    v_and_b32 v45, s89, v76
    v_fmac_f32 v120, v53, v44
    v_fmac_f32 v121, v53, v45
    v_lshlrev_b32 v44, 16, v77
    v_and_b32 v45, s89, v77
    v_fmac_f32 v122, v53, v44
    v_fmac_f32 v123, v53, v45
    v_lshlrev_b32 v44, 16, v78
    v_and_b32 v45, s89, v78
    v_fmac_f32 v124, v53, v44
    v_fmac_f32 v125, v53, v45
    v_lshlrev_b32 v44, 16, v79
    v_and_b32 v45, s89, v79
    v_fmac_f32 v126, v53, v44
    v_fmac_f32 v127, v53, v45
    v_lshlrev_b32 v44, 16, v80
    v_and_b32 v45, s89, v80
    v_mul_f32 v128, v54, v44
    v_mul_f32 v129, v54, v45
    v_lshlrev_b32 v44, 16, v81
    v_and_b32 v45, s89, v81
    v_mul_f32 v130, v54, v44
    v_mul_f32 v131, v54, v45
    v_lshlrev_b32 v44, 16, v82
    v_and_b32 v45, s89, v82
    v_mul_f32 v132, v54, v44
    v_mul_f32 v133, v54, v45
    v_lshlrev_b32 v44, 16, v83
    v_and_b32 v45, s89, v83
    v_mul_f32 v134, v54, v44
    v_mul_f32 v135, v54, v45
    s_mul_i32 s90, s82, 1920
    v_mul_u32_u24 v8, 320, v60
    v_lshlrev_b32 v9, 5, v61
    v_add3_u32 v8, v8, v9, s90
    s_mov_b32 exec_hi, 0x0fffffff
    ds_write_b128 v8, v[120:123] offset:11264
    ds_write_b128 v8, v[124:127] offset:11280
    ds_write_b128 v8, v[128:131] offset:26624
    ds_write_b128 v8, v[132:135] offset:26640
    s_mov_b64 exec, -1
    s_waitcnt lgkmcnt(0)
    s_barrier
    s_cmp_ge_u32 s82, 3
    s_cbranch_scc1 L_tail_sync
    v_cmp_le_u32 vcc, 80, v0
    v_mov_b32 v8, 0
    v_mov_b32 v9, 15040
    v_cndmask_b32 v8, v8, v9, vcc
    v_add_u32 v8, v8, v7
    ds_read_b32 v140, v8 offset:11264
    ds_read_b32 v141, v8 offset:11584
    ds_read_b32 v142, v8 offset:11904
    ds_read_b32 v143, v8 offset:12224
    ds_read_b32 v144, v8 offset:12544
    ds_read_b32 v145, v8 offset:12864
    ds_read_b32 v146, v8 offset:13184
    ds_read_b32 v147, v8 offset:13504
    ds_read_b32 v148, v8 offset:13824
    ds_read_b32 v149, v8 offset:14144
    ds_read_b32 v150, v8 offset:14464
    ds_read_b32 v151, v8 offset:14784
    ds_read_b32 v152, v8 offset:15104
    ds_read_b32 v153, v8 offset:15424
    ds_read_b32 v154, v8 offset:15744
    ds_read_b32 v155, v8 offset:16064
    ds_read_b32 v156, v8 offset:16384
    ds_read_b32 v157, v8 offset:16704
    ds_read_b32 v158, v8 offset:17024
    ds_read_b32 v159, v8 offset:17344
    ds_read_b32 v160, v8 offset:17664
    ds_read_b32 v161, v8 offset:17984
    ds_read_b32 v162, v8 offset:18304
    ds_read_b32 v163, v8 offset:18624
    ds_read_b32 v164, v8 offset:18944
    ds_read_b32 v165, v8 offset:19264
    ds_read_b32 v166, v8 offset:19584
    ds_read_b32 v167, v8 offset:19904
    ds_read_b32 v168, v8 offset:20224
    ds_read_b32 v169, v8 offset:20544
    ds_read_b32 v170, v8 offset:20864
    ds_read_b32 v171, v8 offset:21184
    ds_read_b32 v172, v8 offset:21504
    ds_read_b32 v173, v8 offset:21824
    ds_read_b32 v174, v8 offset:22144
    ds_read_b32 v175, v8 offset:22464
    ds_read_b32 v176, v8 offset:22784
    ds_read_b32 v177, v8 offset:23104
    ds_read_b32 v178, v8 offset:23424
    ds_read_b32 v179, v8 offset:23744
    ds_read_b32 v180, v8 offset:24064
    ds_read_b32 v181, v8 offset:24384
    ds_read_b32 v182, v8 offset:24704
    ds_read_b32 v183, v8 offset:25024
    ds_read_b32 v184, v8 offset:25344
    ds_read_b32 v185, v8 offset:25664
    ds_read_b32 v186, v8 offset:25984
    ds_read_b32 v187, v8 offset:26304
    s_waitcnt lgkmcnt(0)
    v_add_f32 v140, v140, v164
    v_add_f32 v141, v141, v165
    v_add_f32 v142, v142, v166
    v_add_f32 v143, v143, v167
    v_add_f32 v144, v144, v168
    v_add_f32 v145, v145, v169
    v_add_f32 v146, v146, v170
    v_add_f32 v147, v147, v171
    v_add_f32 v148, v148, v172
    v_add_f32 v149, v149, v173
    v_add_f32 v150, v150, v174
    v_add_f32 v151, v151, v175
    v_add_f32 v152, v152, v176
    v_add_f32 v153, v153, v177
    v_add_f32 v154, v154, v178
    v_add_f32 v155, v155, v179
    v_add_f32 v156, v156, v180
    v_add_f32 v157, v157, v181
    v_add_f32 v158, v158, v182
    v_add_f32 v159, v159, v183
    v_add_f32 v160, v160, v184
    v_add_f32 v161, v161, v185
    v_add_f32 v162, v162, v186
    v_add_f32 v163, v163, v187
    v_add_f32 v140, v140, v152
    v_add_f32 v141, v141, v153
    v_add_f32 v142, v142, v154
    v_add_f32 v143, v143, v155
    v_add_f32 v144, v144, v156
    v_add_f32 v145, v145, v157
    v_add_f32 v146, v146, v158
    v_add_f32 v147, v147, v159
    v_add_f32 v148, v148, v160
    v_add_f32 v149, v149, v161
    v_add_f32 v150, v150, v162
    v_add_f32 v151, v151, v163
    v_add_f32 v140, v140, v146
    v_add_f32 v141, v141, v147
    v_add_f32 v142, v142, v148
    v_add_f32 v143, v143, v149
    v_add_f32 v144, v144, v150
    v_add_f32 v145, v145, v151
    v_add_f32 v140, v140, v143
    v_add_f32 v141, v141, v144
    v_add_f32 v142, v142, v145
    v_add_f32 v140, v140, v141
    v_add_f32 v140, v140, v142
    s_lshl_b32 s90, s81, 5
    s_add_u32 s90, s90, s80
    s_mul_i32 s90, s90, 640
    s_add_u32 s90, s90, 1048576
    v_cmp_gt_u32 vcc, 160, v0
    s_nop 1
    s_and_saveexec_b64 s[30:31], vcc
    buffer_store_dword v140, v7, s[56:59], s90 offen sc0 sc1
    s_mov_b64 exec, -1
L_tail_sync:
    s_nop 3
    s_waitcnt vmcnt(0)
    s_barrier
    s_cmp_lg_u32 s82, 0
    s_cbranch_scc1 L_tail_w
    s_mov_b64 exec, 1
    v_mov_b32 v8, 1
    s_lshl_b32 s90, s81, 2
    s_add_u32 s90, s90, 128
    v_mov_b32 v9, s90
    buffer_atomic_add v8, v9, s[76:79], 0 offen sc0 sc1
    s_waitcnt vmcnt(0)
    v_mov_b32 v9, 43008
    ds_write_b32 v9, v8
    s_mov_b64 exec, -1
L_tail_w:
    s_nop 3
    s_waitcnt lgkmcnt(0)
    s_barrier
    v_mov_b32 v9, 43008
    ds_read_b32 v8, v9
    s_waitcnt lgkmcnt(0)
    v_readfirstlane_b32 s90, v8
    s_nop 1
    s_cmp_lg_u32 s90, 31
    s_cbranch_scc1 L_exit
    s_cmp_ge_u32 s82, 3
    s_cbranch_scc1 L_tail_fin2
    s_mul_i32 s90, s81, 20480
    s_add_u32 s90, s90, 1048576
    buffer_load_dword v140, v7, s[56:59], s90 offen sc0 sc1
    s_add_u32 s90, s90, 640
    buffer_load_dword v141, v7, s[56:59], s90 offen sc0 sc1
    s_add_u32 s90, s90, 640
    buffer_load_dword v142, v7, s[56:59], s90 offen sc0 sc1
    s_add_u32 s90, s90, 640
    buffer_load_dword v143, v7, s[56:59], s90 offen sc0 sc1
    s_add_u32 s90, s90, 640
    buffer_load_dword v144, v7, s[56:59], s90 offen sc0 sc1
    s_add_u32 s90, s90, 640
    buffer_load_dword v145, v7, s[56:59], s90 offen sc0 sc1
    s_add_u32 s90, s90, 640
    buffer_load_dword v146, v7, s[56:59], s90 offen sc0 sc1
    s_add_u32 s90, s90, 640
    buffer_load_dword v147, v7, s[56:59], s90 offen sc0 sc1
    s_add_u32 s90, s90, 640
    buffer_load_dword v148, v7, s[56:59], s90 offen sc0 sc1
    s_add_u32 s90, s90, 640
    buffer_load_dword v149, v7, s[56:59], s90 offen sc0 sc1
    s_add_u32 s90, s90, 640
    buffer_load_dword v150, v7, s[56:59], s90 offen sc0 sc1
    s_add_u32 s90, s90, 640
    buffer_load_dword v151, v7, s[56:59], s90 offen sc0 sc1
    s_add_u32 s90, s90, 640
    buffer_load_dword v152, v7, s[56:59], s90 offen sc0 sc1
    s_add_u32 s90, s90, 640
    buffer_load_dword v153, v7, s[56:59], s90 offen sc0 sc1
    s_add_u32 s90, s90, 640
    buffer_load_dword v154, v7, s[56:59], s90 offen sc0 sc1
    s_add_u32 s90, s90, 640
    buffer_load_dword v155, v7, s[56:59], s90 offen sc0 sc1
    s_add_u32 s90, s90, 640
    buffer_load_dword v156, v7, s[56:59], s90 offen sc0 sc1
    s_add_u32 s90, s90, 640
    buffer_load_dword v157, v7, s[56:59], s90 offen sc0 sc1
    s_add_u32 s90, s90, 640
    buffer_load_dword v158, v7, s[56:59], s90 offen sc0 sc1
    s_add_u32 s90, s90, 640
    buffer_load_dword v159, v7, s[56:59], s90 offen sc0 sc1
    s_add_u32 s90, s90, 640
    buffer_load_dword v160, v7, s[56:59], s90 offen sc0 sc1
    s_add_u32 s90, s90, 640
    buffer_load_dword v161, v7, s[56:59], s90 offen sc0 sc1
    s_add_u32 s90, s90, 640
    buffer_load_dword v162, v7, s[56:59], s90 offen sc0 sc1
    s_add_u32 s90, s90, 640
    buffer_load_dword v163, v7, s[56:59], s90 offen sc0 sc1
    s_add_u32 s90, s90, 640
    buffer_load_dword v164, v7, s[56:59], s90 offen sc0 sc1
    s_add_u32 s90, s90, 640
    buffer_load_dword v165, v7, s[56:59], s90 offen sc0 sc1
    s_add_u32 s90, s90, 640
    buffer_load_dword v166, v7, s[56:59], s90 offen sc0 sc1
    s_add_u32 s90, s90, 640
    buffer_load_dword v167, v7, s[56:59], s90 offen sc0 sc1
    s_add_u32 s90, s90, 640
    buffer_load_dword v168, v7, s[56:59], s90 offen sc0 sc1
    s_add_u32 s90, s90, 640
    buffer_load_dword v169, v7, s[56:59], s90 offen sc0 sc1
    s_add_u32 s90, s90, 640
    buffer_load_dword v170, v7, s[56:59], s90 offen sc0 sc1
    s_add_u32 s90, s90, 640
    buffer_load_dword v171, v7, s[56:59], s90 offen sc0 sc1
    s_waitcnt vmcnt(0)
    v_add_f32 v140, v140, v156
    v_add_f32 v141, v141, v157
    v_add_f32 v142, v142, v158
    v_add_f32 v143, v143, v159
    v_add_f32 v144, v144, v160
    v_add_f32 v145, v145, v161
    v_add_f32 v146, v146, v162
    v_add_f32 v147, v147, v163
    v_add_f32 v148, v148, v164
    v_add_f32 v149, v149, v165
    v_add_f32 v150, v150, v166
    v_add_f32 v151, v151, v167
    v_add_f32 v152, v152, v168
    v_add_f32 v153, v153, v169
    v_add_f32 v154, v154, v170
    v_add_f32 v155, v155, v171
    v_add_f32 v140, v140, v148
    v_add_f32 v141, v141, v149
    v_add_f32 v142, v142, v150
    v_add_f32 v143, v143, v151
    v_add_f32 v144, v144, v152
    v_add_f32 v145, v145, v153
    v_add_f32 v146, v146, v154
    v_add_f32 v147, v147, v155
    v_add_f32 v140, v140, v144
    v_add_f32 v141, v141, v145
    v_add_f32 v142, v142, v146
    v_add_f32 v143, v143, v147
    v_add_f32 v140, v140, v142
    v_add_f32 v141, v141, v143
    v_add_f32 v140, v140, v141
    v_cvt_pk_bf16_f32 v141, v140, v140
    v_lshlrev_b32 v140, 16, v141
    ds_write_b32 v7, v140 offset:41984
L_tail_fin2:
    s_nop 3
    s_waitcnt lgkmcnt(0)
    s_barrier
    s_cmp_ge_u32 s82, 2
    s_cbranch_scc1 L_exit
    ds_read_b32 v8, v7 offset:41984
    ds_read_b32 v9, v7 offset:42304
    s_waitcnt lgkmcnt(0)
    v_mul_f32 v8, s91, v8
    v_mov_b32 v10, s91
    v_sub_f32 v10, 1.0, v10
    v_cvt_pk_bf16_f32 v11, v10, v10
    v_lshlrev_b32 v10, 16, v11
    v_mul_f32 v9, v10, v9
    v_cvt_pk_bf16_f32 v11, v8, v9
    v_lshlrev_b32 v8, 16, v11
    v_and_b32 v9, s89, v11
    v_add_f32 v8, v8, v9
    v_cvt_pk_bf16_f32 v8, v8, v8
    s_mul_i32 s90, s81, 160
    v_lshlrev_b32 v9, 1, v0
    v_cmp_gt_u32 vcc, 80, v0
    s_nop 1
    s_and_saveexec_b64 s[30:31], vcc
    buffer_store_short v8, v9, s[72:75], s90 offen
    s_mov_b64 exec, -1
L_exit:
    s_endpgm
.section .rodata,"a"
.p2align 6
.amdhsa_kernel gated_mix__gqa_block_cached__glu_gated_bilinear__decode_kernel
  .amdhsa_next_free_vgpr 256
  .amdhsa_next_free_sgpr 102
  .amdhsa_accum_offset 256
  .amdhsa_group_segment_fixed_size 0
  .amdhsa_kernarg_size 104
  .amdhsa_user_sgpr_count 2
  .amdhsa_user_sgpr_kernarg_segment_ptr 1
  .amdhsa_system_sgpr_workgroup_id_x 1
.end_amdhsa_kernel
```
